```python
import torch

def _softmax(x, axis=-1):
    return torch.softmax(x, dim=axis)
def _gelu(x):
    return torch.nn.functional.gelu(x, approximate="tanh")
def _silu(x):
    return torch.nn.functional.silu(x)
def _sigmoid(x):
    return torch.sigmoid(x)
def _layernorm(x, axis=-1, eps=1e-5):
    m = x.mean(dim=axis, keepdim=True)
    v = x.var(dim=axis, keepdim=True, unbiased=False)
    return (x - m) / torch.sqrt(v + eps)
def _scatter_add(tgt, idx, src, axis=0):
    return tgt.clone().index_add_(axis, idx, src)
def _segment_sum(src, seg, n):
    out = torch.zeros((n,) + src.shape[1:], dtype=src.dtype)
    return out.index_add_(0, seg, src)
def _pad(x, pw):
    flat = tuple(v for pair in reversed(pw) for v in pair)
    return torch.nn.functional.pad(x, flat)

kernel_name = 'recurrent_scan__ssm_conv_s4d__dense_activation_gelu__prompt'

def setup_inputs():

    _w = (lambda a: (lambda t: t.to(torch.bfloat16) if t.is_floating_point() else t)(torch.as_tensor(a)))
    def _A_setup():
        Bsz, L, D, N = 1, 2048, 512, 128
        return {
            "u": _w((lambda *s: torch.randn(*s, dtype=torch.bfloat16) * 0.05)(Bsz, L, D)),
            "log_A_real": _w((lambda *s: torch.randn(*s, dtype=torch.bfloat16) * 6.4)(D, N) * 0.5),
            "A_imag": _w((lambda *s: torch.randn(*s, dtype=torch.bfloat16) * 0.2)(D, N) * 3.14),
            "C_real": _w((lambda *s: torch.randn(*s, dtype=torch.bfloat16) * 0.4)(D, N) / N ** 0.5),
            "C_imag": _w((lambda *s: torch.randn(*s, dtype=torch.bfloat16) * 0.4)(D, N) / N ** 0.5),
            "log_dt": _w((lambda *s: torch.randn(*s, dtype=torch.bfloat16) * 0.2)(D) * 0.5 - 4.0),
            "D_skip": _w((lambda *s: torch.randn(*s, dtype=torch.bfloat16) * 0.2)(D)),
        }
    _A_in = _A_setup()

    def _B_setup():
        B, S, D, F = 1, 2048, 512, 1792
        return {
            "x": _w((lambda *s: torch.randn(*s, dtype=torch.bfloat16) * 0.05)(B, S, D)),
            "w1": _w((lambda *s: torch.randn(*s, dtype=torch.bfloat16) * 0.8)(D, F) * (D ** -0.5)),
            "b1": _w((lambda *s: torch.randn(*s, dtype=torch.bfloat16) * 0.1)(F) * 0.01),
            "w2": _w((lambda *s: torch.randn(*s, dtype=torch.bfloat16) * 0.1)(F, D) * (F ** -0.5)),
            "b2": _w((lambda *s: torch.randn(*s, dtype=torch.bfloat16) * 0.1)(D) * 0.01),
        }
    _B_in = _B_setup()

    return {
        "A_u": _A_in["u"],
        "A_log_A_real": _A_in["log_A_real"],
        "A_A_imag": _A_in["A_imag"],
        "A_C_real": _A_in["C_real"],
        "A_C_imag": _A_in["C_imag"],
        "A_log_dt": _A_in["log_dt"],
        "A_D_skip": _A_in["D_skip"],
        "B_x": _B_in["x"],
        "B_w1": _B_in["w1"],
        "B_b1": _B_in["b1"],
        "B_w2": _B_in["w2"],
        "B_b2": _B_in["b2"],
    }

def reference(A_u, A_log_A_real, A_A_imag, A_C_real, A_C_imag, A_log_dt, A_D_skip, B_x, B_w1, B_b1, B_w2, B_b2):
    def _A_ref(u, log_A_real, A_imag, C_real, C_imag, log_dt, D_skip):
        L = u.shape[1]
        dt = torch.exp(log_dt)
        A = -torch.exp(log_A_real) + 1j * A_imag
        C = (C_real + 1j * C_imag) * dt[:, None]
        pos = (lambda x, dt: x.to(dt))(torch.arange(L), log_dt.dtype)
        P = torch.exp((A * dt[:, None])[:, :, None] * pos[None, None, :])
        K = 2.0 * torch.einsum("dn,dnl->dl", C, P).real
        L2 = 2 * L
        u_t = (lambda x, *d: x.permute(*d))(u, 0, 2, 1)
        Kf = (lambda x, *a, **k: torch.fft.rfft(x.float(), *a, **k))(K, L2)
        Uf = (lambda x, *a, **k: torch.fft.rfft(x.float(), *a, **k))(u_t, L2)
        y = (lambda x, *a, **k: torch.fft.irfft(x, *a, **k).to(torch.bfloat16))(Uf * Kf[None, :, :], L2)[:, :, :L]
        y = (lambda x, *d: x.permute(*d))(y, 0, 2, 1)
        return y + u * D_skip[None, None, :]

    def _B_ref(x, w1, b1, w2, b2):
        h = torch.einsum("bsd,df->bsf", x, w1) + b1
        h = _gelu(h)
        return torch.einsum("bsf,fd->bsd", h, w2) + b2

    x = A_u
    xn = _layernorm(x, axis=-1)
    s = _A_ref(xn, A_log_A_real, A_A_imag, A_C_real, A_C_imag, A_log_dt, A_D_skip)
    g = _silu(_B_ref(xn, B_w1, B_b1, B_w2, B_b2))
    return x + s * g
```

```asm
; @launch kernel=fin_kernel grid=(512,1,1) block=(512,1,1) lds=81920
.amdgcn_target "amdgcn-amd-amdhsa--gfx950"
.text
.globl fin_kernel
.p2align 8
.type fin_kernel,@function
fin_kernel:
    s_cmp_ge_u32 s2, 512
    s_cbranch_scc1 F_done
    s_load_dwordx2 s[4:5], s[0:1], 112
    s_load_dwordx4 s[8:11], s[0:1], 80
    s_load_dwordx2 s[6:7], s[0:1], 0
    s_load_dwordx2 s[12:13], s[0:1], 96
    s_load_dwordx2 s[14:15], s[0:1], 48
    s_load_dwordx2 s[16:17], s[0:1], 104
    s_load_dwordx4 s[72:75], s[0:1], 64
    s_load_dwordx8 s[76:83], s[0:1], 8
    s_load_dwordx2 s[84:85], s[0:1], 40
    v_and_b32 v1, 63, v0
    v_lshrrev_b32 v2, 6, v0
    s_mov_b32 s64, 0xffff0000
    v_readfirstlane_b32 s46, v2
    s_cmp_ge_u32 s2, 256
    s_cbranch_scc1 F_conv
    s_setprio 2
    s_waitcnt lgkmcnt(0)
    s_mov_b32 s24, s4
    s_mov_b32 s25, s5
    s_mov_b32 s26, 0x1400000
    s_mov_b32 s27, 0x00020000
    s_mov_b32 s68, s16
    s_mov_b32 s69, s17
    s_mov_b32 s70, 0x100
    s_mov_b32 s71, 0x00020000
    s_mov_b32 s28, s6
    s_mov_b32 s29, s7
    s_mov_b32 s30, 0x200000
    s_mov_b32 s31, 0x00020000
    v_lshlrev_b32 v3, 4, v1
    v_lshl_add_u32 v3, v2, 10, v3
    s_bfe_u32 s87, s2, 0x20001
    s_lshl_b32 s87, s87, 6
    s_lshr_b32 s3, s2, 3
    s_lshl_b32 s3, s3, 1
    s_add_u32 s87, s87, s3
    s_and_b32 s3, s2, 1
    s_add_u32 s87, s87, s3
    s_lshl_b32 s3, s87, 13
    buffer_load_dwordx4 v[8:11], v3, s[28:31], s3 offen
    s_lshl_b32 s40, s2, 3
    s_add_u32 s40, s40, s46
    s_cmp_lg_u32 s40, 7
    s_cbranch_scc1 LN_noinit
    v_lshlrev_b32 v4, 8, v1
    v_mov_b32 v5, 0
    s_mov_b32 s40, 0x6a0000
    buffer_store_dword v5, v4, s[24:27], s40 offen sc1
    v_mov_b32 v6, 1
    s_waitcnt vmcnt(0)
    s_mov_b64 exec, 1
    buffer_store_dword v6, v5, s[68:71], 0 offen sc1
    s_mov_b64 exec, -1
LN_noinit:
    v_mul_u32_u24 v4, 1088, v2
    v_lshl_add_u32 v4, v1, 4, v4
    v_bfe_u32 v5, v1, 2, 2
    v_mul_u32_u24 v5, 1088, v5
    v_lshrrev_b32 v6, 4, v1
    v_lshl_add_u32 v5, v6, 5, v5
    v_and_b32 v6, 3, v1
    v_lshl_add_u32 v5, v6, 3, v5
    v_lshl_add_u32 v5, v2, 7, v5
    v_lshlrev_b32 v7, 4, v0
    s_add_u32 s40, s3, 0x200000
    s_waitcnt vmcnt(0)
    v_lshlrev_b32 v24, 16, v8
    v_and_b32 v25, s64, v8
    v_lshlrev_b32 v26, 16, v9
    v_and_b32 v27, s64, v9
    v_lshlrev_b32 v28, 16, v10
    v_and_b32 v29, s64, v10
    v_lshlrev_b32 v30, 16, v11
    v_and_b32 v31, s64, v11
    v_pk_add_f32 v[72:73], v[24:25], v[26:27]
    v_pk_add_f32 v[74:75], v[28:29], v[30:31]
    s_nop 0
    v_pk_add_f32 v[72:73], v[72:73], v[74:75]
    s_nop 0
    v_add_f32 v56, v72, v73
    s_nop 1
    v_add_f32_dpp v56, v56, v56 quad_perm:[1,0,3,2] row_mask:0xf bank_mask:0xf
    s_nop 1
    v_add_f32_dpp v56, v56, v56 quad_perm:[2,3,0,1] row_mask:0xf bank_mask:0xf
    s_nop 1
    v_add_f32_dpp v56, v56, v56 row_half_mirror row_mask:0xf bank_mask:0xf
    s_nop 1
    v_add_f32_dpp v56, v56, v56 row_mirror row_mask:0xf bank_mask:0xf
    v_mov_b32 v57, v56
    s_nop 1
    v_permlane16_swap_b32 v56, v57
    v_add_f32 v56, v56, v57
    v_mov_b32 v57, v56
    s_nop 1
    v_permlane32_swap_b32 v56, v57
    v_add_f32 v56, v56, v57
    v_mul_f32 v56, 0x3b000000, v56
    v_pk_add_f32 v[72:73], v[24:25], v[56:57] op_sel_hi:[1,0] neg_lo:[0,1] neg_hi:[0,1]
    v_pk_add_f32 v[74:75], v[26:27], v[56:57] op_sel_hi:[1,0] neg_lo:[0,1] neg_hi:[0,1]
    v_pk_add_f32 v[76:77], v[28:29], v[56:57] op_sel_hi:[1,0] neg_lo:[0,1] neg_hi:[0,1]
    v_pk_add_f32 v[78:79], v[30:31], v[56:57] op_sel_hi:[1,0] neg_lo:[0,1] neg_hi:[0,1]
    v_pk_mul_f32 v[80:81], v[72:73], v[72:73]
    s_nop 0
    v_pk_fma_f32 v[80:81], v[74:75], v[74:75], v[80:81]
    s_nop 0
    v_pk_fma_f32 v[80:81], v[76:77], v[76:77], v[80:81]
    s_nop 0
    v_pk_fma_f32 v[80:81], v[78:79], v[78:79], v[80:81]
    s_nop 0
    v_add_f32 v58, v80, v81
    s_nop 1
    v_add_f32_dpp v58, v58, v58 quad_perm:[1,0,3,2] row_mask:0xf bank_mask:0xf
    s_nop 1
    v_add_f32_dpp v58, v58, v58 quad_perm:[2,3,0,1] row_mask:0xf bank_mask:0xf
    s_nop 1
    v_add_f32_dpp v58, v58, v58 row_half_mirror row_mask:0xf bank_mask:0xf
    s_nop 1
    v_add_f32_dpp v58, v58, v58 row_mirror row_mask:0xf bank_mask:0xf
    v_mov_b32 v57, v58
    s_nop 1
    v_permlane16_swap_b32 v58, v57
    v_add_f32 v58, v58, v57
    v_mov_b32 v57, v58
    s_nop 1
    v_permlane32_swap_b32 v58, v57
    v_add_f32 v58, v58, v57
    v_mul_f32 v58, 0x3b000000, v58
    v_cvt_pk_bf16_f32 v57, v56, v58
    v_lshlrev_b32 v56, 16, v57
    v_and_b32 v58, s64, v57
    v_add_f32 v58, 0x3727c5ac, v58
    v_cvt_pk_bf16_f32 v58, v58, v58
    v_and_b32 v58, s64, v58
    v_sqrt_f32 v58, v58
    s_nop 0
    v_cvt_pk_bf16_f32 v58, v58, v58
    v_and_b32 v58, s64, v58
    v_rcp_f32 v58, v58
    s_mov_b32 s42, 0x44800000
    v_pk_add_f32 v[24:25], v[24:25], v[56:57] op_sel_hi:[1,0] neg_lo:[0,1] neg_hi:[0,1]
    v_pk_add_f32 v[26:27], v[26:27], v[56:57] op_sel_hi:[1,0] neg_lo:[0,1] neg_hi:[0,1]
    v_pk_add_f32 v[28:29], v[28:29], v[56:57] op_sel_hi:[1,0] neg_lo:[0,1] neg_hi:[0,1]
    v_pk_add_f32 v[30:31], v[30:31], v[56:57] op_sel_hi:[1,0] neg_lo:[0,1] neg_hi:[0,1]
    v_cvt_pk_bf16_f32 v8, v24, v25
    v_cvt_pk_bf16_f32 v9, v26, v27
    v_cvt_pk_bf16_f32 v10, v28, v29
    v_cvt_pk_bf16_f32 v11, v30, v31
    v_lshlrev_b32 v24, 16, v8
    v_and_b32 v25, s64, v8
    v_lshlrev_b32 v26, 16, v9
    v_and_b32 v27, s64, v9
    v_lshlrev_b32 v28, 16, v10
    v_and_b32 v29, s64, v10
    v_lshlrev_b32 v30, 16, v11
    v_and_b32 v31, s64, v11
    v_pk_mul_f32 v[24:25], v[24:25], v[58:59] op_sel_hi:[1,0]
    v_pk_mul_f32 v[26:27], v[26:27], v[58:59] op_sel_hi:[1,0]
    v_pk_mul_f32 v[28:29], v[28:29], v[58:59] op_sel_hi:[1,0]
    v_pk_mul_f32 v[30:31], v[30:31], v[58:59] op_sel_hi:[1,0]
    v_cvt_pk_bf16_f32 v8, v24, v25
    v_cvt_pk_bf16_f32 v9, v26, v27
    v_cvt_pk_bf16_f32 v10, v28, v29
    v_cvt_pk_bf16_f32 v11, v30, v31
    buffer_store_dwordx4 v[8:11], v3, s[24:27], s3 offen sc1
    v_lshlrev_b32 v24, 16, v8
    v_and_b32 v25, s64, v8
    v_lshlrev_b32 v26, 16, v9
    v_and_b32 v27, s64, v9
    v_lshlrev_b32 v28, 16, v10
    v_and_b32 v29, s64, v10
    v_lshlrev_b32 v30, 16, v11
    v_and_b32 v31, s64, v11
    v_pk_mul_f32 v[24:25], v[24:25], s[42:43] op_sel_hi:[1,0]
    v_pk_mul_f32 v[26:27], v[26:27], s[42:43] op_sel_hi:[1,0]
    v_pk_mul_f32 v[28:29], v[28:29], s[42:43] op_sel_hi:[1,0]
    v_pk_mul_f32 v[30:31], v[30:31], s[42:43] op_sel_hi:[1,0]
    v_cvt_pk_f16_f32 v72, v24, v25
    v_cvt_pk_f16_f32 v73, v26, v27
    v_cvt_pk_f16_f32 v74, v28, v29
    v_cvt_pk_f16_f32 v75, v30, v31
    ds_write_b128 v4, v[72:75]
    s_waitcnt lgkmcnt(0)
    s_barrier
    ds_read_b64_tr_b16 v[24:25], v5
    ds_read_b64_tr_b16 v[26:27], v5 offset:4352
    s_waitcnt lgkmcnt(0)
    buffer_store_dwordx4 v[24:27], v7, s[24:27], s40 offen sc1
    s_waitcnt vmcnt(0)
    s_barrier
    s_cmp_lg_u32 s46, 0
    s_cbranch_scc1 LN_sig
    v_mov_b32 v4, 0
    s_mov_b32 s86, 0
LN_wi:
    buffer_load_dword v5, v4, s[68:71], 0 offen sc1
    s_waitcnt vmcnt(0)
    v_readfirstlane_b32 s52, v5
    s_nop 0
    s_cmp_lg_u32 s52, 0
    s_cbranch_scc1 LN_wi_ok
    s_sleep 16
    s_add_u32 s86, s86, 1
    s_cmp_lt_u32 s86, 0x40000
    s_cbranch_scc1 LN_wi
LN_wi_ok:
    v_mov_b32 v24, 1
    v_mov_b32 v25, 0
    s_lshr_b32 s40, s87, 4
    s_lshl_b32 s40, s40, 8
    s_add_u32 s40, s40, 0x6a1100
    s_mov_b64 exec, 1
    buffer_atomic_add v24, v25, s[24:27], s40 offen sc1
    s_mov_b64 exec, -1
LN_sig:
    s_cmp_lt_u32 s2, 224
    s_cbranch_scc1 F_g1
    s_waitcnt vmcnt(0)
    s_barrier
    s_setprio 0
    s_cmp_lt_u32 s46, 4
    s_cbranch_scc1 F_g2
    v_and_b32 v2, 3, v2
    s_mov_b32 s36, s8
    s_mov_b32 s37, s9
    s_mov_b32 s38, 0x1c0000
    s_mov_b32 s39, 0x00020000
    s_lshr_b32 s40, s2, 3
    s_mul_i32 s40, s40, 57344
    v_lshl_add_u32 v12, v2, 6, v1
    v_lshlrev_b32 v12, 7, v12
    buffer_load_dword v14, v12, s[36:39], s40 offen
    s_add_u32 s40, s40, 32768
    buffer_load_dword v15, v12, s[36:39], s40 offen
    s_branch F_g2
F_g1:
    s_mov_b32 s28, s72
    s_mov_b32 s29, s73
    s_mov_b32 s30, 0x1c0000
    s_mov_b32 s31, 0x00020000
    s_mov_b32 s32, s74
    s_mov_b32 s33, s75
    s_mov_b32 s34, 0xe00
    s_mov_b32 s35, 0x00020000
    s_and_b32 s40, s2, 7
    s_lshr_b32 s41, s2, 3
    s_mul_i32 s42, s41, 37
    s_lshr_b32 s42, s42, 8
    s_mul_i32 s43, s42, 7
    s_sub_u32 s43, s41, s43
    s_lshr_b32 s44, s40, 1
    s_lshl_b32 s44, s44, 2
    s_add_u32 s44, s44, s42
    s_and_b32 s45, s40, 1
    s_mul_i32 s45, s45, 7
    s_add_u32 s45, s45, s43
    s_cmp_lt_u32 s46, 4
    s_cbranch_scc1 G1_compute
    s_sub_u32 s46, s46, 4
    v_and_b32 v2, 3, v2
    v_lshrrev_b32 v3, 4, v1
    v_and_b32 v4, 3, v1
    v_xor_b32 v4, v4, v3
    v_lshlrev_b32 v4, 4, v4
    v_lshrrev_b32 v5, 2, v1
    v_lshl_add_u32 v10, v5, 10, v4
    v_lshlrev_b32 v4, 2, v3
    v_and_b32 v5, 15, v1
    v_xor_b32 v4, v4, v5
    v_lshlrev_b32 v4, 4, v4
    v_mul_u32_u24 v5, 3584, v3
    v_add_u32 v11, v4, v5
    s_lshl_b32 s48, s44, 17
    s_lshl_b32 s50, s46, 14
    s_add_u32 s48, s48, s50
    s_mul_i32 s49, s46, 14336
    s_lshl_b32 s50, s45, 8
    s_add_u32 s49, s49, s50
    s_lshl_b32 s51, s46, 10
    s_add_u32 s47, s51, 81920
    s_lshl_b32 s60, s42, 1
    s_add_u32 s60, s60, s43
    s_and_b32 s60, s60, 7
    s_lshl_b32 s60, s60, 1
    s_mov_b32 s58, s60
    s_mov_b32 s59, s51
    s_lshl_b32 s62, s60, 6
    s_add_u32 s62, s62, s48
    s_mul_i32 s63, s60, 114688
    s_add_u32 s63, s63, s49
    s_add_u32 s52, s63, 0
    s_add_u32 m0, s51, 8192
    s_nop 0
    buffer_load_dwordx4 v11, s[28:31], s52 offen lds
    s_add_u32 s52, s63, 57344
    s_add_u32 m0, s51, 12288
    s_nop 0
    buffer_load_dwordx4 v11, s[28:31], s52 offen lds
    s_add_u32 s60, s60, 1
    s_and_b32 s60, s60, 15
    s_add_u32 s51, s51, 16384
    s_sub_u32 s66, s51, 81920
    s_cmp_ge_u32 s51, s47
    s_cselect_b32 s51, s66, s51
    s_lshl_b32 s62, s60, 6
    s_add_u32 s62, s62, s48
    s_mul_i32 s63, s60, 114688
    s_add_u32 s63, s63, s49
    s_add_u32 s52, s63, 0
    s_add_u32 m0, s51, 8192
    s_nop 0
    buffer_load_dwordx4 v11, s[28:31], s52 offen lds
    s_add_u32 s52, s63, 57344
    s_add_u32 m0, s51, 12288
    s_nop 0
    buffer_load_dwordx4 v11, s[28:31], s52 offen lds
    s_add_u32 s60, s60, 1
    s_and_b32 s60, s60, 15
    s_add_u32 s51, s51, 16384
    s_sub_u32 s66, s51, 81920
    s_cmp_ge_u32 s51, s47
    s_cselect_b32 s51, s66, s51
    s_lshl_b32 s62, s60, 6
    s_add_u32 s62, s62, s48
    s_mul_i32 s63, s60, 114688
    s_add_u32 s63, s63, s49
    s_add_u32 s52, s63, 0
    s_add_u32 m0, s51, 8192
    s_nop 0
    buffer_load_dwordx4 v11, s[28:31], s52 offen lds
    s_add_u32 s52, s63, 57344
    s_add_u32 m0, s51, 12288
    s_nop 0
    buffer_load_dwordx4 v11, s[28:31], s52 offen lds
    s_add_u32 s60, s60, 1
    s_and_b32 s60, s60, 15
    s_add_u32 s51, s51, 16384
    s_sub_u32 s66, s51, 81920
    s_cmp_ge_u32 s51, s47
    s_cselect_b32 s51, s66, s51
    s_lshl_b32 s62, s60, 6
    s_add_u32 s62, s62, s48
    s_mul_i32 s63, s60, 114688
    s_add_u32 s63, s63, s49
    s_add_u32 s52, s63, 0
    s_add_u32 m0, s51, 8192
    s_nop 0
    buffer_load_dwordx4 v11, s[28:31], s52 offen lds
    s_add_u32 s52, s63, 57344
    s_add_u32 m0, s51, 12288
    s_nop 0
    buffer_load_dwordx4 v11, s[28:31], s52 offen lds
    s_add_u32 s60, s60, 1
    s_and_b32 s60, s60, 15
    s_add_u32 s51, s51, 16384
    s_sub_u32 s66, s51, 81920
    s_cmp_ge_u32 s51, s47
    s_cselect_b32 s51, s66, s51
    s_mov_b32 s60, s58
    s_mov_b32 s51, s59
    s_setprio 0
    s_barrier
    s_setprio 2
    s_lshl_b32 s62, s60, 6
    s_add_u32 s62, s62, s48
    s_mul_i32 s63, s60, 114688
    s_add_u32 s63, s63, s49
    s_add_u32 s52, s62, 0
    s_add_u32 m0, s51, 0
    s_nop 0
    buffer_load_dwordx4 v10, s[24:27], s52 offen sc1 lds
    s_add_u32 s52, s62, 65536
    s_add_u32 m0, s51, 4096
    s_nop 0
    buffer_load_dwordx4 v10, s[24:27], s52 offen sc1 lds
    s_add_u32 s60, s60, 1
    s_and_b32 s60, s60, 15
    s_add_u32 s51, s51, 16384
    s_sub_u32 s66, s51, 81920
    s_cmp_ge_u32 s51, s47
    s_cselect_b32 s51, s66, s51
    s_lshl_b32 s62, s60, 6
    s_add_u32 s62, s62, s48
    s_mul_i32 s63, s60, 114688
    s_add_u32 s63, s63, s49
    s_add_u32 s52, s62, 0
    s_add_u32 m0, s51, 0
    s_nop 0
    buffer_load_dwordx4 v10, s[24:27], s52 offen sc1 lds
    s_add_u32 s52, s62, 65536
    s_add_u32 m0, s51, 4096
    s_nop 0
    buffer_load_dwordx4 v10, s[24:27], s52 offen sc1 lds
    s_add_u32 s60, s60, 1
    s_and_b32 s60, s60, 15
    s_add_u32 s51, s51, 16384
    s_sub_u32 s66, s51, 81920
    s_cmp_ge_u32 s51, s47
    s_cselect_b32 s51, s66, s51
    s_lshl_b32 s62, s60, 6
    s_add_u32 s62, s62, s48
    s_mul_i32 s63, s60, 114688
    s_add_u32 s63, s63, s49
    s_add_u32 s52, s62, 0
    s_add_u32 m0, s51, 0
    s_nop 0
    buffer_load_dwordx4 v10, s[24:27], s52 offen sc1 lds
    s_add_u32 s52, s62, 65536
    s_add_u32 m0, s51, 4096
    s_nop 0
    buffer_load_dwordx4 v10, s[24:27], s52 offen sc1 lds
    s_add_u32 s60, s60, 1
    s_and_b32 s60, s60, 15
    s_add_u32 s51, s51, 16384
    s_sub_u32 s66, s51, 81920
    s_cmp_ge_u32 s51, s47
    s_cselect_b32 s51, s66, s51
    s_lshl_b32 s62, s60, 6
    s_add_u32 s62, s62, s48
    s_mul_i32 s63, s60, 114688
    s_add_u32 s63, s63, s49
    s_add_u32 s52, s62, 0
    s_add_u32 m0, s51, 0
    s_nop 0
    buffer_load_dwordx4 v10, s[24:27], s52 offen sc1 lds
    s_add_u32 s52, s62, 65536
    s_add_u32 m0, s51, 4096
    s_nop 0
    buffer_load_dwordx4 v10, s[24:27], s52 offen sc1 lds
    s_add_u32 s60, s60, 1
    s_and_b32 s60, s60, 15
    s_add_u32 s51, s51, 16384
    s_sub_u32 s66, s51, 81920
    s_cmp_ge_u32 s51, s47
    s_cselect_b32 s51, s66, s51
    s_waitcnt vmcnt(6)
    s_barrier
    s_waitcnt vmcnt(4)
    s_barrier
    s_lshl_b32 s62, s60, 6
    s_add_u32 s62, s62, s48
    s_mul_i32 s63, s60, 114688
    s_add_u32 s63, s63, s49
    s_add_u32 s52, s62, 0
    s_add_u32 m0, s51, 0
    s_nop 0
    buffer_load_dwordx4 v10, s[24:27], s52 offen sc1 lds
    s_add_u32 s52, s62, 65536
    s_add_u32 m0, s51, 4096
    s_nop 0
    buffer_load_dwordx4 v10, s[24:27], s52 offen sc1 lds
    s_add_u32 s52, s63, 0
    s_add_u32 m0, s51, 8192
    s_nop 0
    buffer_load_dwordx4 v11, s[28:31], s52 offen lds
    s_add_u32 s52, s63, 57344
    s_add_u32 m0, s51, 12288
    s_nop 0
    buffer_load_dwordx4 v11, s[28:31], s52 offen lds
    s_add_u32 s60, s60, 1
    s_and_b32 s60, s60, 15
    s_add_u32 s51, s51, 16384
    s_sub_u32 s66, s51, 81920
    s_cmp_ge_u32 s51, s47
    s_cselect_b32 s51, s66, s51
    s_waitcnt vmcnt(6)
    s_barrier
    s_lshl_b32 s62, s60, 6
    s_add_u32 s62, s62, s48
    s_mul_i32 s63, s60, 114688
    s_add_u32 s63, s63, s49
    s_add_u32 s52, s62, 0
    s_add_u32 m0, s51, 0
    s_nop 0
    buffer_load_dwordx4 v10, s[24:27], s52 offen sc1 lds
    s_add_u32 s52, s62, 65536
    s_add_u32 m0, s51, 4096
    s_nop 0
    buffer_load_dwordx4 v10, s[24:27], s52 offen sc1 lds
    s_add_u32 s52, s63, 0
    s_add_u32 m0, s51, 8192
    s_nop 0
    buffer_load_dwordx4 v11, s[28:31], s52 offen lds
    s_add_u32 s52, s63, 57344
    s_add_u32 m0, s51, 12288
    s_nop 0
    buffer_load_dwordx4 v11, s[28:31], s52 offen lds
    s_add_u32 s60, s60, 1
    s_and_b32 s60, s60, 15
    s_add_u32 s51, s51, 16384
    s_sub_u32 s66, s51, 81920
    s_cmp_ge_u32 s51, s47
    s_cselect_b32 s51, s66, s51
    s_mov_b32 s65, 6
G1L_loop:
    s_waitcnt vmcnt(8)
    s_barrier
    s_lshl_b32 s62, s60, 6
    s_add_u32 s62, s62, s48
    s_mul_i32 s63, s60, 114688
    s_add_u32 s63, s63, s49
    s_add_u32 s52, s62, 0
    s_add_u32 m0, s51, 0
    s_nop 0
    buffer_load_dwordx4 v10, s[24:27], s52 offen sc1 lds
    s_add_u32 s52, s62, 65536
    s_add_u32 m0, s51, 4096
    s_nop 0
    buffer_load_dwordx4 v10, s[24:27], s52 offen sc1 lds
    s_add_u32 s52, s63, 0
    s_add_u32 m0, s51, 8192
    s_nop 0
    buffer_load_dwordx4 v11, s[28:31], s52 offen lds
    s_add_u32 s52, s63, 57344
    s_add_u32 m0, s51, 12288
    s_nop 0
    buffer_load_dwordx4 v11, s[28:31], s52 offen lds
    s_add_u32 s60, s60, 1
    s_and_b32 s60, s60, 15
    s_add_u32 s51, s51, 16384
    s_sub_u32 s66, s51, 81920
    s_cmp_ge_u32 s51, s47
    s_cselect_b32 s51, s66, s51
    s_add_u32 s65, s65, 1
    s_cmp_lt_u32 s65, 16
    s_cbranch_scc1 G1L_loop
    s_waitcnt vmcnt(8)
    s_barrier
    s_waitcnt vmcnt(4)
    s_barrier
    s_waitcnt vmcnt(0)
    s_barrier
    s_barrier
    s_mov_b32 s67, 1
    v_lshrrev_b32 v5, 5, v1
    v_lshrrev_b32 v6, 1, v2
    v_lshlrev_b32 v3, 7, v6
    v_lshl_add_u32 v3, v5, 3, v3
    s_lshl_b32 s50, s45, 8
    s_lshl_b32 s53, s67, 6
    s_add_u32 s53, s53, s50
    buffer_load_dwordx2 v[24:25], v3, s[32:35], s53 offen offset:0
    buffer_load_dwordx2 v[26:27], v3, s[32:35], s53 offen offset:16
    buffer_load_dwordx2 v[28:29], v3, s[32:35], s53 offen offset:32
    buffer_load_dwordx2 v[30:31], v3, s[32:35], s53 offen offset:48
    v_lshl_add_u32 v7, v6, 3, v5
    s_lshl_b32 s53, s67, 2
    v_add_u32 v7, s53, v7
    v_and_b32 v9, 15, v1
    v_xor_b32 v7, v7, v9
    v_lshlrev_b32 v7, 4, v7
    v_and_b32 v10, 31, v1
    v_and_b32 v11, 1, v2
    v_lshl_add_u32 v10, v11, 6, v10
    v_lshl_add_u32 v10, v10, 8, v7
    v_add_u32 v10, 49152, v10
    v_xor_b32 v11, 32, v10
    v_add_u32 v7, s53, v2
    v_lshrrev_b32 v15, 4, v1
    v_xor_b32 v14, v9, v15
    v_lshlrev_b32 v14, 4, v14
    v_lshl_add_u32 v15, v7, 4, v15
    v_lshl_add_u32 v14, v15, 8, v14
    v_add_u32 v14, 49152, v14
    v_mul_u32_u24 v15, 3584, v15
    v_lshl_add_u32 v15, v9, 4, v15
    s_mul_i32 s52, s44, 128*3584
    s_add_u32 s52, s52, s50
    s_add_u32 s52, s52, 0x900000
    s_mov_b32 s54, 0xbdd2d3e8
    v_mov_b32 v8, 0xc0135761
    v_lshlrev_b32 v4, 4, v1
    v_lshl_add_u32 v4, v2, 13, v4
    s_mov_b32 s36, s8
    s_mov_b32 s37, s9
    s_mov_b32 s38, 0x1c0000
    s_mov_b32 s39, 0x00020000
    s_lshr_b32 s40, s2, 3
    s_mul_i32 s40, s40, 57344
    v_lshlrev_b32 v22, 7, v0
    buffer_load_dword v23, v22, s[36:39], s40 offen
    s_barrier
    ds_read_b128 v[64:67], v4 offset:16384
    ds_read_b128 v[68:71], v4 offset:17408
    ds_read_b128 v[72:75], v4 offset:18432
    ds_read_b128 v[76:79], v4 offset:19456
    ds_read_b128 v[80:83], v4 offset:20480
    ds_read_b128 v[84:87], v4 offset:21504
    ds_read_b128 v[88:91], v4 offset:22528
    ds_read_b128 v[92:95], v4 offset:23552
    s_waitcnt lgkmcnt(0)
    s_branch G1_epi
G1_compute:
    v_and_b32 v4, 31, v1
    v_lshrrev_b32 v5, 5, v1
    v_bfe_u32 v6, v1, 2, 2
    v_xor_b32 v6, v6, v5
    v_lshlrev_b32 v6, 4, v6
    v_and_b32 v7, 1, v2
    v_lshl_add_u32 v7, v7, 6, v4
    v_lshl_add_u32 v12, v7, 6, v6
    v_xor_b32 v13, 32, v12
    v_bfe_u32 v4, v1, 2, 2
    v_lshrrev_b32 v6, 5, v1
    v_lshl_add_u32 v6, v6, 3, v4
    v_lshlrev_b32 v6, 8, v6
    v_bfe_u32 v7, v1, 4, 1
    v_lshl_add_u32 v6, v7, 5, v6
    v_and_b32 v7, 3, v1
    v_lshl_add_u32 v6, v7, 3, v6
    v_add_u32 v6, 8192, v6
    v_and_b32 v7, 2, v2
    v_xor_b32 v8, v7, v4
    v_lshl_add_u32 v16, v8, 6, v6
    v_or_b32 v7, 1, v7
    v_xor_b32 v8, v7, v4
    v_lshl_add_u32 v17, v8, 6, v6
    v_mov_b64 v[64:65], 0
    v_mov_b64 v[66:67], 0
    v_mov_b64 v[68:69], 0
    v_mov_b64 v[70:71], 0
    v_mov_b64 v[72:73], 0
    v_mov_b64 v[74:75], 0
    v_mov_b64 v[76:77], 0
    v_mov_b64 v[78:79], 0
    v_mov_b64 v[80:81], 0
    v_mov_b64 v[82:83], 0
    v_mov_b64 v[84:85], 0
    v_mov_b64 v[86:87], 0
    v_mov_b64 v[88:89], 0
    v_mov_b64 v[90:91], 0
    v_mov_b64 v[92:93], 0
    v_mov_b64 v[94:95], 0
    v_mov_b64 v[96:97], 0
    v_mov_b64 v[98:99], 0
    v_mov_b64 v[100:101], 0
    v_mov_b64 v[102:103], 0
    v_mov_b64 v[104:105], 0
    v_mov_b64 v[106:107], 0
    v_mov_b64 v[108:109], 0
    v_mov_b64 v[110:111], 0
    v_mov_b64 v[112:113], 0
    v_mov_b64 v[114:115], 0
    v_mov_b64 v[116:117], 0
    v_mov_b64 v[118:119], 0
    v_mov_b64 v[120:121], 0
    v_mov_b64 v[122:123], 0
    v_mov_b64 v[124:125], 0
    v_mov_b64 v[126:127], 0
    s_mov_b32 s60, 0
    s_mov_b32 s65, 0
    s_mov_b32 s67, 0
    v_lshrrev_b32 v5, 5, v1
    v_lshrrev_b32 v6, 1, v2
    v_lshlrev_b32 v3, 7, v6
    v_lshl_add_u32 v3, v5, 3, v3
    s_lshl_b32 s50, s45, 8
    s_lshl_b32 s53, s67, 6
    s_add_u32 s53, s53, s50
    buffer_load_dwordx2 v[24:25], v3, s[32:35], s53 offen offset:0
    buffer_load_dwordx2 v[26:27], v3, s[32:35], s53 offen offset:16
    buffer_load_dwordx2 v[28:29], v3, s[32:35], s53 offen offset:32
    buffer_load_dwordx2 v[30:31], v3, s[32:35], s53 offen offset:48
    v_lshl_add_u32 v7, v6, 3, v5
    s_lshl_b32 s53, s67, 2
    v_add_u32 v7, s53, v7
    v_and_b32 v9, 15, v1
    v_xor_b32 v7, v7, v9
    v_lshlrev_b32 v7, 4, v7
    v_and_b32 v10, 31, v1
    v_and_b32 v11, 1, v2
    v_lshl_add_u32 v10, v11, 6, v10
    v_lshl_add_u32 v10, v10, 8, v7
    v_add_u32 v10, 49152, v10
    v_xor_b32 v11, 32, v10
    v_add_u32 v7, s53, v2
    v_lshrrev_b32 v15, 4, v1
    v_xor_b32 v14, v9, v15
    v_lshlrev_b32 v14, 4, v14
    v_lshl_add_u32 v15, v7, 4, v15
    v_lshl_add_u32 v14, v15, 8, v14
    v_add_u32 v14, 49152, v14
    v_mul_u32_u24 v15, 3584, v15
    v_lshl_add_u32 v15, v9, 4, v15
    s_mul_i32 s52, s44, 128*3584
    s_add_u32 s52, s52, s50
    s_add_u32 s52, s52, 0x900000
    s_mov_b32 s54, 0xbdd2d3e8
    v_mov_b32 v8, 0xc0135761
    v_lshlrev_b32 v4, 4, v1
    v_lshl_add_u32 v4, v2, 13, v4
    v_add_u32 v18, s60, v12
    v_add_u32 v19, s60, v13
    v_add_u32 v20, s60, v16
    v_add_u32 v21, s60, v17
    s_add_u32 s60, s60, 16384
    s_cmp_eq_u32 s60, 81920
    s_cselect_b32 s60, 0, s60
    s_setprio 0
    s_cmp_lg_u32 s46, 0
    s_cbranch_scc1 G1_go
    s_lshl_b32 s61, s44, 8
    s_add_u32 s61, s61, 0x6a1100
    v_mov_b32 v22, 0
    s_mov_b32 s86, 0
G1_poll:
    buffer_load_dword v23, v22, s[24:27], s61 offen sc1
    s_waitcnt vmcnt(0)
    v_readfirstlane_b32 s62, v23
    s_nop 0
    s_cmp_ge_u32 s62, 16
    s_cbranch_scc1 G1_go
    s_sleep 8
    s_add_u32 s86, s86, 1
    s_cmp_lt_u32 s86, 0x40000
    s_cbranch_scc1 G1_poll
G1_go:
    s_barrier
    s_setprio 2
    s_barrier
    ds_read_b128 v[32:35], v18 offset:0
    ds_read_b128 v[36:39], v18 offset:2048
    ds_read_b64_tr_b16 v[40:41], v20 offset:0
    ds_read_b64_tr_b16 v[42:43], v20 offset:1024
    ds_read_b64_tr_b16 v[44:45], v21 offset:0
    ds_read_b64_tr_b16 v[46:47], v21 offset:1024
G1C_loop:
    s_barrier
    ds_read_b128 v[48:51], v19 offset:0
    ds_read_b128 v[52:55], v19 offset:2048
    ds_read_b64_tr_b16 v[56:57], v20 offset:4096
    ds_read_b64_tr_b16 v[58:59], v20 offset:5120
    ds_read_b64_tr_b16 v[60:61], v21 offset:4096
    ds_read_b64_tr_b16 v[62:63], v21 offset:5120
    v_add_u32 v18, s60, v12
    v_add_u32 v19, s60, v13
    v_add_u32 v20, s60, v16
    v_add_u32 v21, s60, v17
    s_add_u32 s60, s60, 16384
    s_cmp_eq_u32 s60, 81920
    s_cselect_b32 s60, 0, s60
    s_waitcnt lgkmcnt(6)
    v_mfma_f32_32x32x16_bf16 v[64:79], v[40:43], v[32:35], v[64:79]
    v_mfma_f32_32x32x16_bf16 v[80:95], v[40:43], v[36:39], v[80:95]
    v_mfma_f32_32x32x16_bf16 v[96:111], v[44:47], v[32:35], v[96:111]
    v_mfma_f32_32x32x16_bf16 v[112:127], v[44:47], v[36:39], v[112:127]
    ds_read_b128 v[32:35], v18 offset:0
    ds_read_b128 v[36:39], v18 offset:2048
    ds_read_b64_tr_b16 v[40:41], v20 offset:0
    ds_read_b64_tr_b16 v[42:43], v20 offset:1024
    ds_read_b64_tr_b16 v[44:45], v21 offset:0
    ds_read_b64_tr_b16 v[46:47], v21 offset:1024
    s_add_u32 s65, s65, 1
    s_waitcnt lgkmcnt(6)
    v_mfma_f32_32x32x16_bf16 v[64:79], v[56:59], v[48:51], v[64:79]
    v_mfma_f32_32x32x16_bf16 v[80:95], v[56:59], v[52:55], v[80:95]
    v_mfma_f32_32x32x16_bf16 v[96:111], v[60:63], v[48:51], v[96:111]
    v_mfma_f32_32x32x16_bf16 v[112:127], v[60:63], v[52:55], v[112:127]
    s_cmp_lt_u32 s65, 16
    s_cbranch_scc1 G1C_loop
    s_waitcnt lgkmcnt(0)
    s_mov_b32 s36, s8
    s_mov_b32 s37, s9
    s_mov_b32 s38, 0x1c0000
    s_mov_b32 s39, 0x00020000
    s_lshr_b32 s40, s2, 3
    s_mul_i32 s40, s40, 57344
    v_lshlrev_b32 v22, 7, v0
    buffer_load_dword v23, v22, s[36:39], s40 offen
    s_nop 15
    s_nop 15
    s_nop 11
    ds_write_b128 v4, v[96:99] offset:16384
    ds_write_b128 v4, v[100:103] offset:17408
    ds_write_b128 v4, v[104:107] offset:18432
    ds_write_b128 v4, v[108:111] offset:19456
    ds_write_b128 v4, v[112:115] offset:20480
    ds_write_b128 v4, v[116:119] offset:21504
    ds_write_b128 v4, v[120:123] offset:22528
    ds_write_b128 v4, v[124:127] offset:23552
    s_waitcnt lgkmcnt(0)
    s_barrier
G1_epi:
    s_waitcnt vmcnt(1)
    v_lshlrev_b32 v48, 16, v24
    v_and_b32 v49, s64, v24
    v_lshlrev_b32 v50, 16, v25
    v_and_b32 v51, s64, v25
    v_lshlrev_b32 v52, 16, v26
    v_and_b32 v53, s64, v26
    v_lshlrev_b32 v54, 16, v27
    v_and_b32 v55, s64, v27
    v_lshlrev_b32 v56, 16, v28
    v_and_b32 v57, s64, v28
    v_lshlrev_b32 v58, 16, v29
    v_and_b32 v59, s64, v29
    v_lshlrev_b32 v60, 16, v30
    v_and_b32 v61, s64, v30
    v_lshlrev_b32 v62, 16, v31
    v_and_b32 v63, s64, v31
    v_cvt_pk_bf16_f32 v32, v64, v65
    v_cvt_pk_bf16_f32 v33, v66, v67
    v_cvt_pk_bf16_f32 v34, v68, v69
    v_cvt_pk_bf16_f32 v35, v70, v71
    v_cvt_pk_bf16_f32 v36, v72, v73
    v_cvt_pk_bf16_f32 v37, v74, v75
    v_cvt_pk_bf16_f32 v38, v76, v77
    v_cvt_pk_bf16_f32 v39, v78, v79
    v_lshlrev_b32 v64, 16, v32
    v_and_b32 v65, s64, v32
    v_lshlrev_b32 v66, 16, v33
    v_and_b32 v67, s64, v33
    v_lshlrev_b32 v68, 16, v34
    v_and_b32 v69, s64, v34
    v_lshlrev_b32 v70, 16, v35
    v_and_b32 v71, s64, v35
    v_lshlrev_b32 v72, 16, v36
    v_and_b32 v73, s64, v36
    v_lshlrev_b32 v74, 16, v37
    v_and_b32 v75, s64, v37
    v_lshlrev_b32 v76, 16, v38
    v_and_b32 v77, s64, v38
    v_lshlrev_b32 v78, 16, v39
    v_and_b32 v79, s64, v39
    v_pk_add_f32 v[64:65], v[64:65], v[48:49]
    v_pk_add_f32 v[66:67], v[66:67], v[50:51]
    v_pk_add_f32 v[68:69], v[68:69], v[52:53]
    v_pk_add_f32 v[70:71], v[70:71], v[54:55]
    v_pk_add_f32 v[72:73], v[72:73], v[56:57]
    v_pk_add_f32 v[74:75], v[74:75], v[58:59]
    v_pk_add_f32 v[76:77], v[76:77], v[60:61]
    v_pk_add_f32 v[78:79], v[78:79], v[62:63]
    v_cvt_pk_bf16_f32 v32, v64, v65
    v_cvt_pk_bf16_f32 v33, v66, v67
    v_cvt_pk_bf16_f32 v34, v68, v69
    v_cvt_pk_bf16_f32 v35, v70, v71
    v_cvt_pk_bf16_f32 v36, v72, v73
    v_cvt_pk_bf16_f32 v37, v74, v75
    v_cvt_pk_bf16_f32 v38, v76, v77
    v_cvt_pk_bf16_f32 v39, v78, v79
    v_lshlrev_b32 v64, 16, v32
    v_and_b32 v65, s64, v32
    v_lshlrev_b32 v66, 16, v33
    v_and_b32 v67, s64, v33
    v_lshlrev_b32 v68, 16, v34
    v_and_b32 v69, s64, v34
    v_lshlrev_b32 v70, 16, v35
    v_and_b32 v71, s64, v35
    v_lshlrev_b32 v72, 16, v36
    v_and_b32 v73, s64, v36
    v_lshlrev_b32 v74, 16, v37
    v_and_b32 v75, s64, v37
    v_lshlrev_b32 v76, 16, v38
    v_and_b32 v77, s64, v38
    v_lshlrev_b32 v78, 16, v39
    v_and_b32 v79, s64, v39
    v_pk_mul_f32 v[32:33], v[64:65], v[64:65]
    v_pk_mul_f32 v[34:35], v[66:67], v[66:67]
    v_pk_mul_f32 v[36:37], v[68:69], v[68:69]
    v_pk_mul_f32 v[38:39], v[70:71], v[70:71]
    v_pk_mul_f32 v[40:41], v[72:73], v[72:73]
    v_pk_mul_f32 v[42:43], v[74:75], v[74:75]
    v_pk_mul_f32 v[44:45], v[76:77], v[76:77]
    v_pk_mul_f32 v[46:47], v[78:79], v[78:79]
    v_pk_fma_f32 v[32:33], v[32:33], s[54:55], v[8:9] op_sel_hi:[1,0,0]
    v_pk_fma_f32 v[34:35], v[34:35], s[54:55], v[8:9] op_sel_hi:[1,0,0]
    v_pk_fma_f32 v[36:37], v[36:37], s[54:55], v[8:9] op_sel_hi:[1,0,0]
    v_pk_fma_f32 v[38:39], v[38:39], s[54:55], v[8:9] op_sel_hi:[1,0,0]
    v_pk_fma_f32 v[40:41], v[40:41], s[54:55], v[8:9] op_sel_hi:[1,0,0]
    v_pk_fma_f32 v[42:43], v[42:43], s[54:55], v[8:9] op_sel_hi:[1,0,0]
    v_pk_fma_f32 v[44:45], v[44:45], s[54:55], v[8:9] op_sel_hi:[1,0,0]
    v_pk_fma_f32 v[46:47], v[46:47], s[54:55], v[8:9] op_sel_hi:[1,0,0]
    v_pk_mul_f32 v[32:33], v[32:33], v[64:65]
    v_pk_mul_f32 v[34:35], v[34:35], v[66:67]
    v_pk_mul_f32 v[36:37], v[36:37], v[68:69]
    v_pk_mul_f32 v[38:39], v[38:39], v[70:71]
    v_pk_mul_f32 v[40:41], v[40:41], v[72:73]
    v_pk_mul_f32 v[42:43], v[42:43], v[74:75]
    v_pk_mul_f32 v[44:45], v[44:45], v[76:77]
    v_pk_mul_f32 v[46:47], v[46:47], v[78:79]
    v_exp_f32 v32, v32
    v_exp_f32 v33, v33
    v_exp_f32 v34, v34
    v_exp_f32 v35, v35
    v_exp_f32 v36, v36
    v_exp_f32 v37, v37
    v_exp_f32 v38, v38
    v_exp_f32 v39, v39
    v_exp_f32 v40, v40
    v_exp_f32 v41, v41
    v_exp_f32 v42, v42
    v_exp_f32 v43, v43
    v_exp_f32 v44, v44
    v_exp_f32 v45, v45
    v_exp_f32 v46, v46
    v_exp_f32 v47, v47
    v_pk_add_f32 v[32:33], v[32:33], 1.0 op_sel_hi:[1,0]
    v_pk_add_f32 v[34:35], v[34:35], 1.0 op_sel_hi:[1,0]
    v_pk_add_f32 v[36:37], v[36:37], 1.0 op_sel_hi:[1,0]
    v_pk_add_f32 v[38:39], v[38:39], 1.0 op_sel_hi:[1,0]
    v_pk_add_f32 v[40:41], v[40:41], 1.0 op_sel_hi:[1,0]
    v_pk_add_f32 v[42:43], v[42:43], 1.0 op_sel_hi:[1,0]
    v_pk_add_f32 v[44:45], v[44:45], 1.0 op_sel_hi:[1,0]
    v_pk_add_f32 v[46:47], v[46:47], 1.0 op_sel_hi:[1,0]
    v_rcp_f32 v32, v32
    v_rcp_f32 v33, v33
    v_rcp_f32 v34, v34
    v_rcp_f32 v35, v35
    v_rcp_f32 v36, v36
    v_rcp_f32 v37, v37
    v_rcp_f32 v38, v38
    v_rcp_f32 v39, v39
    v_rcp_f32 v40, v40
    v_rcp_f32 v41, v41
    v_rcp_f32 v42, v42
    v_rcp_f32 v43, v43
    v_rcp_f32 v44, v44
    v_rcp_f32 v45, v45
    v_rcp_f32 v46, v46
    v_rcp_f32 v47, v47
    v_pk_mul_f32 v[32:33], v[32:33], v[64:65]
    v_pk_mul_f32 v[34:35], v[34:35], v[66:67]
    v_pk_mul_f32 v[36:37], v[36:37], v[68:69]
    v_pk_mul_f32 v[38:39], v[38:39], v[70:71]
    v_pk_mul_f32 v[40:41], v[40:41], v[72:73]
    v_pk_mul_f32 v[42:43], v[42:43], v[74:75]
    v_pk_mul_f32 v[44:45], v[44:45], v[76:77]
    v_pk_mul_f32 v[46:47], v[46:47], v[78:79]
    v_cvt_pk_bf16_f32 v64, v32, v33
    v_cvt_pk_bf16_f32 v65, v34, v35
    v_cvt_pk_bf16_f32 v66, v36, v37
    v_cvt_pk_bf16_f32 v67, v38, v39
    v_cvt_pk_bf16_f32 v68, v40, v41
    v_cvt_pk_bf16_f32 v69, v42, v43
    v_cvt_pk_bf16_f32 v70, v44, v45
    v_cvt_pk_bf16_f32 v71, v46, v47
    v_permlane32_swap_b32 v64, v66
    v_permlane32_swap_b32 v65, v67
    v_permlane32_swap_b32 v68, v70
    v_permlane32_swap_b32 v69, v71
    ds_write_b128 v10, v[64:67] offset:0
    ds_write_b128 v11, v[68:71] offset:0
    v_cvt_pk_bf16_f32 v32, v80, v81
    v_cvt_pk_bf16_f32 v33, v82, v83
    v_cvt_pk_bf16_f32 v34, v84, v85
    v_cvt_pk_bf16_f32 v35, v86, v87
    v_cvt_pk_bf16_f32 v36, v88, v89
    v_cvt_pk_bf16_f32 v37, v90, v91
    v_cvt_pk_bf16_f32 v38, v92, v93
    v_cvt_pk_bf16_f32 v39, v94, v95
    v_lshlrev_b32 v80, 16, v32
    v_and_b32 v81, s64, v32
    v_lshlrev_b32 v82, 16, v33
    v_and_b32 v83, s64, v33
    v_lshlrev_b32 v84, 16, v34
    v_and_b32 v85, s64, v34
    v_lshlrev_b32 v86, 16, v35
    v_and_b32 v87, s64, v35
    v_lshlrev_b32 v88, 16, v36
    v_and_b32 v89, s64, v36
    v_lshlrev_b32 v90, 16, v37
    v_and_b32 v91, s64, v37
    v_lshlrev_b32 v92, 16, v38
    v_and_b32 v93, s64, v38
    v_lshlrev_b32 v94, 16, v39
    v_and_b32 v95, s64, v39
    v_pk_add_f32 v[80:81], v[80:81], v[48:49]
    v_pk_add_f32 v[82:83], v[82:83], v[50:51]
    v_pk_add_f32 v[84:85], v[84:85], v[52:53]
    v_pk_add_f32 v[86:87], v[86:87], v[54:55]
    v_pk_add_f32 v[88:89], v[88:89], v[56:57]
    v_pk_add_f32 v[90:91], v[90:91], v[58:59]
    v_pk_add_f32 v[92:93], v[92:93], v[60:61]
    v_pk_add_f32 v[94:95], v[94:95], v[62:63]
    v_cvt_pk_bf16_f32 v32, v80, v81
    v_cvt_pk_bf16_f32 v33, v82, v83
    v_cvt_pk_bf16_f32 v34, v84, v85
    v_cvt_pk_bf16_f32 v35, v86, v87
    v_cvt_pk_bf16_f32 v36, v88, v89
    v_cvt_pk_bf16_f32 v37, v90, v91
    v_cvt_pk_bf16_f32 v38, v92, v93
    v_cvt_pk_bf16_f32 v39, v94, v95
    v_lshlrev_b32 v80, 16, v32
    v_and_b32 v81, s64, v32
    v_lshlrev_b32 v82, 16, v33
    v_and_b32 v83, s64, v33
    v_lshlrev_b32 v84, 16, v34
    v_and_b32 v85, s64, v34
    v_lshlrev_b32 v86, 16, v35
    v_and_b32 v87, s64, v35
    v_lshlrev_b32 v88, 16, v36
    v_and_b32 v89, s64, v36
    v_lshlrev_b32 v90, 16, v37
    v_and_b32 v91, s64, v37
    v_lshlrev_b32 v92, 16, v38
    v_and_b32 v93, s64, v38
    v_lshlrev_b32 v94, 16, v39
    v_and_b32 v95, s64, v39
    v_pk_mul_f32 v[32:33], v[80:81], v[80:81]
    v_pk_mul_f32 v[34:35], v[82:83], v[82:83]
    v_pk_mul_f32 v[36:37], v[84:85], v[84:85]
    v_pk_mul_f32 v[38:39], v[86:87], v[86:87]
    v_pk_mul_f32 v[40:41], v[88:89], v[88:89]
    v_pk_mul_f32 v[42:43], v[90:91], v[90:91]
    v_pk_mul_f32 v[44:45], v[92:93], v[92:93]
    v_pk_mul_f32 v[46:47], v[94:95], v[94:95]
    v_pk_fma_f32 v[32:33], v[32:33], s[54:55], v[8:9] op_sel_hi:[1,0,0]
    v_pk_fma_f32 v[34:35], v[34:35], s[54:55], v[8:9] op_sel_hi:[1,0,0]
    v_pk_fma_f32 v[36:37], v[36:37], s[54:55], v[8:9] op_sel_hi:[1,0,0]
    v_pk_fma_f32 v[38:39], v[38:39], s[54:55], v[8:9] op_sel_hi:[1,0,0]
    v_pk_fma_f32 v[40:41], v[40:41], s[54:55], v[8:9] op_sel_hi:[1,0,0]
    v_pk_fma_f32 v[42:43], v[42:43], s[54:55], v[8:9] op_sel_hi:[1,0,0]
    v_pk_fma_f32 v[44:45], v[44:45], s[54:55], v[8:9] op_sel_hi:[1,0,0]
    v_pk_fma_f32 v[46:47], v[46:47], s[54:55], v[8:9] op_sel_hi:[1,0,0]
    v_pk_mul_f32 v[32:33], v[32:33], v[80:81]
    v_pk_mul_f32 v[34:35], v[34:35], v[82:83]
    v_pk_mul_f32 v[36:37], v[36:37], v[84:85]
    v_pk_mul_f32 v[38:39], v[38:39], v[86:87]
    v_pk_mul_f32 v[40:41], v[40:41], v[88:89]
    v_pk_mul_f32 v[42:43], v[42:43], v[90:91]
    v_pk_mul_f32 v[44:45], v[44:45], v[92:93]
    v_pk_mul_f32 v[46:47], v[46:47], v[94:95]
    v_exp_f32 v32, v32
    v_exp_f32 v33, v33
    v_exp_f32 v34, v34
    v_exp_f32 v35, v35
    v_exp_f32 v36, v36
    v_exp_f32 v37, v37
    v_exp_f32 v38, v38
    v_exp_f32 v39, v39
    v_exp_f32 v40, v40
    v_exp_f32 v41, v41
    v_exp_f32 v42, v42
    v_exp_f32 v43, v43
    v_exp_f32 v44, v44
    v_exp_f32 v45, v45
    v_exp_f32 v46, v46
    v_exp_f32 v47, v47
    v_pk_add_f32 v[32:33], v[32:33], 1.0 op_sel_hi:[1,0]
    v_pk_add_f32 v[34:35], v[34:35], 1.0 op_sel_hi:[1,0]
    v_pk_add_f32 v[36:37], v[36:37], 1.0 op_sel_hi:[1,0]
    v_pk_add_f32 v[38:39], v[38:39], 1.0 op_sel_hi:[1,0]
    v_pk_add_f32 v[40:41], v[40:41], 1.0 op_sel_hi:[1,0]
    v_pk_add_f32 v[42:43], v[42:43], 1.0 op_sel_hi:[1,0]
    v_pk_add_f32 v[44:45], v[44:45], 1.0 op_sel_hi:[1,0]
    v_pk_add_f32 v[46:47], v[46:47], 1.0 op_sel_hi:[1,0]
    v_rcp_f32 v32, v32
    v_rcp_f32 v33, v33
    v_rcp_f32 v34, v34
    v_rcp_f32 v35, v35
    v_rcp_f32 v36, v36
    v_rcp_f32 v37, v37
    v_rcp_f32 v38, v38
    v_rcp_f32 v39, v39
    v_rcp_f32 v40, v40
    v_rcp_f32 v41, v41
    v_rcp_f32 v42, v42
    v_rcp_f32 v43, v43
    v_rcp_f32 v44, v44
    v_rcp_f32 v45, v45
    v_rcp_f32 v46, v46
    v_rcp_f32 v47, v47
    v_pk_mul_f32 v[32:33], v[32:33], v[80:81]
    v_pk_mul_f32 v[34:35], v[34:35], v[82:83]
    v_pk_mul_f32 v[36:37], v[36:37], v[84:85]
    v_pk_mul_f32 v[38:39], v[38:39], v[86:87]
    v_pk_mul_f32 v[40:41], v[40:41], v[88:89]
    v_pk_mul_f32 v[42:43], v[42:43], v[90:91]
    v_pk_mul_f32 v[44:45], v[44:45], v[92:93]
    v_pk_mul_f32 v[46:47], v[46:47], v[94:95]
    v_cvt_pk_bf16_f32 v80, v32, v33
    v_cvt_pk_bf16_f32 v81, v34, v35
    v_cvt_pk_bf16_f32 v82, v36, v37
    v_cvt_pk_bf16_f32 v83, v38, v39
    v_cvt_pk_bf16_f32 v84, v40, v41
    v_cvt_pk_bf16_f32 v85, v42, v43
    v_cvt_pk_bf16_f32 v86, v44, v45
    v_cvt_pk_bf16_f32 v87, v46, v47
    v_permlane32_swap_b32 v80, v82
    v_permlane32_swap_b32 v81, v83
    v_permlane32_swap_b32 v84, v86
    v_permlane32_swap_b32 v85, v87
    ds_write_b128 v10, v[80:83] offset:8192
    ds_write_b128 v11, v[84:87] offset:8192
    v_xor_b32 v19, 64, v14
    s_add_u32 s57, s52, 14336
    v_xor_b32 v20, 128, v14
    s_add_u32 s58, s52, 28672
    v_xor_b32 v21, 192, v14
    s_add_u32 s59, s52, 43008
    s_waitcnt lgkmcnt(0)
    s_barrier
    ds_read_b128 v[32:35], v14
    ds_read_b128 v[36:39], v19 offset:1024
    ds_read_b128 v[40:43], v20 offset:2048
    ds_read_b128 v[44:47], v21 offset:3072
    s_waitcnt lgkmcnt(3)
    buffer_store_dwordx4 v[32:35], v15, s[24:27], s52 offen sc1
    s_waitcnt lgkmcnt(2)
    buffer_store_dwordx4 v[36:39], v15, s[24:27], s57 offen sc1
    s_waitcnt lgkmcnt(1)
    buffer_store_dwordx4 v[40:43], v15, s[24:27], s58 offen sc1
    s_waitcnt lgkmcnt(0)
    buffer_store_dwordx4 v[44:47], v15, s[24:27], s59 offen sc1
    s_waitcnt vmcnt(0)
    s_barrier
    v_readfirstlane_b32 s46, v0
    s_nop 0
    s_cmp_lg_u32 s46, 0
    s_cbranch_scc1 G1_sigdone
    v_mov_b32 v24, 1
    v_mov_b32 v25, 0
    s_lshl_b32 s46, s44, 8
    s_add_u32 s46, s46, 0x6a0100
    s_mov_b64 exec, 1
    buffer_atomic_add v24, v25, s[24:27], s46 offen sc1
    s_mov_b64 exec, -1
G1_sigdone:
F_g2:
    s_setprio 0
    v_lshrrev_b32 v2, 6, v0
    s_nop 1
    v_readfirstlane_b32 s46, v2
    s_and_b32 s40, s2, 7
    s_lshr_b32 s41, s2, 3
    s_lshr_b32 s44, s41, 3
    s_lshl_b32 s40, s40, 2
    s_add_u32 s44, s44, s40
    s_and_b32 s45, s41, 7
    s_cmp_lt_u32 s46, 4
    s_cbranch_scc1 F_compute
    s_sub_u32 s46, s46, 4
    v_and_b32 v2, 3, v2
    v_lshrrev_b32 v3, 4, v1
    v_and_b32 v4, 1, v2
    v_lshl_add_u32 v4, v4, 2, v3
    v_and_b32 v5, 7, v1
    v_xor_b32 v4, v4, v5
    v_lshlrev_b32 v4, 4, v4
    v_lshrrev_b32 v5, 3, v1
    v_mul_u32_u24 v6, 3584, v5
    v_add_u32 v10, v4, v6
    v_and_b32 v4, 1, v3
    v_lshlrev_b32 v4, 2, v4
    v_and_b32 v6, 7, v1
    v_xor_b32 v4, v4, v6
    v_lshlrev_b32 v4, 4, v4
    v_lshl_add_u32 v11, v5, 10, v4
    s_lshl_b32 s48, s44, 6
    s_lshl_b32 s50, s46, 3
    s_add_u32 s48, s48, s50
    s_mul_i32 s48, s48, 3584
    s_add_u32 s48, s48, 0x900000
    s_lshl_b32 s49, s46, 13
    s_lshl_b32 s50, s45, 7
    s_add_u32 s49, s49, s50
    s_lshl_b32 s51, s46, 10
    s_add_u32 s47, s51, 81920
    s_lshr_b32 s60, s41, 3
    s_lshl_b32 s60, s60, 1
    s_add_u32 s60, s60, s45
    s_lshl_b32 s60, s60, 2
    s_sub_u32 s61, s60, 28
    s_cmp_ge_u32 s60, 28
    s_cselect_b32 s60, s61, s60
    s_mov_b32 s28, s8
    s_mov_b32 s29, s9
    s_mov_b32 s30, 0x1c0000
    s_mov_b32 s31, 0x00020000
    s_mov_b32 s58, s60
    s_mov_b32 s59, s51
    s_lshl_b32 s62, s60, 7
    s_add_u32 s62, s62, s48
    s_lshl_b32 s63, s60, 16
    s_add_u32 s63, s63, s49
    s_add_u32 s52, s63, 0
    s_add_u32 m0, s51, 8192
    s_nop 0
    buffer_load_dwordx4 v11, s[28:31], s52 offen lds
    s_add_u32 s52, s63, 32768
    s_add_u32 m0, s51, 12288
    s_nop 0
    buffer_load_dwordx4 v11, s[28:31], s52 offen lds
    s_add_u32 s60, s60, 1
    s_cmp_eq_u32 s60, 28
    s_cselect_b32 s60, 0, s60
    s_add_u32 s51, s51, 16384
    s_sub_u32 s66, s51, 81920
    s_cmp_ge_u32 s51, s47
    s_cselect_b32 s51, s66, s51
    s_lshl_b32 s62, s60, 7
    s_add_u32 s62, s62, s48
    s_lshl_b32 s63, s60, 16
    s_add_u32 s63, s63, s49
    s_add_u32 s52, s63, 0
    s_add_u32 m0, s51, 8192
    s_nop 0
    buffer_load_dwordx4 v11, s[28:31], s52 offen lds
    s_add_u32 s52, s63, 32768
    s_add_u32 m0, s51, 12288
    s_nop 0
    buffer_load_dwordx4 v11, s[28:31], s52 offen lds
    s_add_u32 s60, s60, 1
    s_cmp_eq_u32 s60, 28
    s_cselect_b32 s60, 0, s60
    s_add_u32 s51, s51, 16384
    s_sub_u32 s66, s51, 81920
    s_cmp_ge_u32 s51, s47
    s_cselect_b32 s51, s66, s51
    s_lshl_b32 s62, s60, 7
    s_add_u32 s62, s62, s48
    s_lshl_b32 s63, s60, 16
    s_add_u32 s63, s63, s49
    s_add_u32 s52, s63, 0
    s_add_u32 m0, s51, 8192
    s_nop 0
    buffer_load_dwordx4 v11, s[28:31], s52 offen lds
    s_add_u32 s52, s63, 32768
    s_add_u32 m0, s51, 12288
    s_nop 0
    buffer_load_dwordx4 v11, s[28:31], s52 offen lds
    s_add_u32 s60, s60, 1
    s_cmp_eq_u32 s60, 28
    s_cselect_b32 s60, 0, s60
    s_add_u32 s51, s51, 16384
    s_sub_u32 s66, s51, 81920
    s_cmp_ge_u32 s51, s47
    s_cselect_b32 s51, s66, s51
    s_lshl_b32 s62, s60, 7
    s_add_u32 s62, s62, s48
    s_lshl_b32 s63, s60, 16
    s_add_u32 s63, s63, s49
    s_add_u32 s52, s63, 0
    s_add_u32 m0, s51, 8192
    s_nop 0
    buffer_load_dwordx4 v11, s[28:31], s52 offen lds
    s_add_u32 s52, s63, 32768
    s_add_u32 m0, s51, 12288
    s_nop 0
    buffer_load_dwordx4 v11, s[28:31], s52 offen lds
    s_add_u32 s60, s60, 1
    s_cmp_eq_u32 s60, 28
    s_cselect_b32 s60, 0, s60
    s_add_u32 s51, s51, 16384
    s_sub_u32 s66, s51, 81920
    s_cmp_ge_u32 s51, s47
    s_cselect_b32 s51, s66, s51
    s_mov_b32 s60, s58
    s_mov_b32 s51, s59
    s_setprio 0
    s_barrier
    s_setprio 2
    s_lshl_b32 s62, s60, 7
    s_add_u32 s62, s62, s48
    s_lshl_b32 s63, s60, 16
    s_add_u32 s63, s63, s49
    s_add_u32 s52, s62, 0
    s_add_u32 m0, s51, 0
    s_nop 0
    buffer_load_dwordx4 v10, s[24:27], s52 offen sc1 lds
    s_add_u32 s52, s62, 114688
    s_add_u32 m0, s51, 4096
    s_nop 0
    buffer_load_dwordx4 v10, s[24:27], s52 offen sc1 lds
    s_add_u32 s60, s60, 1
    s_cmp_eq_u32 s60, 28
    s_cselect_b32 s60, 0, s60
    s_add_u32 s51, s51, 16384
    s_sub_u32 s66, s51, 81920
    s_cmp_ge_u32 s51, s47
    s_cselect_b32 s51, s66, s51
    s_lshl_b32 s62, s60, 7
    s_add_u32 s62, s62, s48
    s_lshl_b32 s63, s60, 16
    s_add_u32 s63, s63, s49
    s_add_u32 s52, s62, 0
    s_add_u32 m0, s51, 0
    s_nop 0
    buffer_load_dwordx4 v10, s[24:27], s52 offen sc1 lds
    s_add_u32 s52, s62, 114688
    s_add_u32 m0, s51, 4096
    s_nop 0
    buffer_load_dwordx4 v10, s[24:27], s52 offen sc1 lds
    s_add_u32 s60, s60, 1
    s_cmp_eq_u32 s60, 28
    s_cselect_b32 s60, 0, s60
    s_add_u32 s51, s51, 16384
    s_sub_u32 s66, s51, 81920
    s_cmp_ge_u32 s51, s47
    s_cselect_b32 s51, s66, s51
    s_lshl_b32 s62, s60, 7
    s_add_u32 s62, s62, s48
    s_lshl_b32 s63, s60, 16
    s_add_u32 s63, s63, s49
    s_add_u32 s52, s62, 0
    s_add_u32 m0, s51, 0
    s_nop 0
    buffer_load_dwordx4 v10, s[24:27], s52 offen sc1 lds
    s_add_u32 s52, s62, 114688
    s_add_u32 m0, s51, 4096
    s_nop 0
    buffer_load_dwordx4 v10, s[24:27], s52 offen sc1 lds
    s_add_u32 s60, s60, 1
    s_cmp_eq_u32 s60, 28
    s_cselect_b32 s60, 0, s60
    s_add_u32 s51, s51, 16384
    s_sub_u32 s66, s51, 81920
    s_cmp_ge_u32 s51, s47
    s_cselect_b32 s51, s66, s51
    s_lshl_b32 s62, s60, 7
    s_add_u32 s62, s62, s48
    s_lshl_b32 s63, s60, 16
    s_add_u32 s63, s63, s49
    s_add_u32 s52, s62, 0
    s_add_u32 m0, s51, 0
    s_nop 0
    buffer_load_dwordx4 v10, s[24:27], s52 offen sc1 lds
    s_add_u32 s52, s62, 114688
    s_add_u32 m0, s51, 4096
    s_nop 0
    buffer_load_dwordx4 v10, s[24:27], s52 offen sc1 lds
    s_add_u32 s60, s60, 1
    s_cmp_eq_u32 s60, 28
    s_cselect_b32 s60, 0, s60
    s_add_u32 s51, s51, 16384
    s_sub_u32 s66, s51, 81920
    s_cmp_ge_u32 s51, s47
    s_cselect_b32 s51, s66, s51
    s_waitcnt vmcnt(6)
    s_barrier
    s_waitcnt vmcnt(4)
    s_barrier
    s_lshl_b32 s62, s60, 7
    s_add_u32 s62, s62, s48
    s_lshl_b32 s63, s60, 16
    s_add_u32 s63, s63, s49
    s_add_u32 s52, s62, 0
    s_add_u32 m0, s51, 0
    s_nop 0
    buffer_load_dwordx4 v10, s[24:27], s52 offen sc1 lds
    s_add_u32 s52, s62, 114688
    s_add_u32 m0, s51, 4096
    s_nop 0
    buffer_load_dwordx4 v10, s[24:27], s52 offen sc1 lds
    s_add_u32 s52, s63, 0
    s_add_u32 m0, s51, 8192
    s_nop 0
    buffer_load_dwordx4 v11, s[28:31], s52 offen lds
    s_add_u32 s52, s63, 32768
    s_add_u32 m0, s51, 12288
    s_nop 0
    buffer_load_dwordx4 v11, s[28:31], s52 offen lds
    s_add_u32 s60, s60, 1
    s_cmp_eq_u32 s60, 28
    s_cselect_b32 s60, 0, s60
    s_add_u32 s51, s51, 16384
    s_sub_u32 s66, s51, 81920
    s_cmp_ge_u32 s51, s47
    s_cselect_b32 s51, s66, s51
    s_waitcnt vmcnt(6)
    s_barrier
    s_lshl_b32 s62, s60, 7
    s_add_u32 s62, s62, s48
    s_lshl_b32 s63, s60, 16
    s_add_u32 s63, s63, s49
    s_add_u32 s52, s62, 0
    s_add_u32 m0, s51, 0
    s_nop 0
    buffer_load_dwordx4 v10, s[24:27], s52 offen sc1 lds
    s_add_u32 s52, s62, 114688
    s_add_u32 m0, s51, 4096
    s_nop 0
    buffer_load_dwordx4 v10, s[24:27], s52 offen sc1 lds
    s_add_u32 s52, s63, 0
    s_add_u32 m0, s51, 8192
    s_nop 0
    buffer_load_dwordx4 v11, s[28:31], s52 offen lds
    s_add_u32 s52, s63, 32768
    s_add_u32 m0, s51, 12288
    s_nop 0
    buffer_load_dwordx4 v11, s[28:31], s52 offen lds
    s_add_u32 s60, s60, 1
    s_cmp_eq_u32 s60, 28
    s_cselect_b32 s60, 0, s60
    s_add_u32 s51, s51, 16384
    s_sub_u32 s66, s51, 81920
    s_cmp_ge_u32 s51, s47
    s_cselect_b32 s51, s66, s51
    s_mov_b32 s65, 6
FL_loop:
    s_waitcnt vmcnt(8)
    s_barrier
    s_lshl_b32 s62, s60, 7
    s_add_u32 s62, s62, s48
    s_lshl_b32 s63, s60, 16
    s_add_u32 s63, s63, s49
    s_add_u32 s52, s62, 0
    s_add_u32 m0, s51, 0
    s_nop 0
    buffer_load_dwordx4 v10, s[24:27], s52 offen sc1 lds
    s_add_u32 s52, s62, 114688
    s_add_u32 m0, s51, 4096
    s_nop 0
    buffer_load_dwordx4 v10, s[24:27], s52 offen sc1 lds
    s_add_u32 s52, s63, 0
    s_add_u32 m0, s51, 8192
    s_nop 0
    buffer_load_dwordx4 v11, s[28:31], s52 offen lds
    s_add_u32 s52, s63, 32768
    s_add_u32 m0, s51, 12288
    s_nop 0
    buffer_load_dwordx4 v11, s[28:31], s52 offen lds
    s_add_u32 s60, s60, 1
    s_cmp_eq_u32 s60, 28
    s_cselect_b32 s60, 0, s60
    s_add_u32 s51, s51, 16384
    s_sub_u32 s66, s51, 81920
    s_cmp_ge_u32 s51, s47
    s_cselect_b32 s51, s66, s51
    s_add_u32 s65, s65, 1
    s_cmp_lt_u32 s65, 28
    s_cbranch_scc1 FL_loop
    s_waitcnt vmcnt(8)
    s_barrier
    s_waitcnt vmcnt(4)
    s_barrier
    s_waitcnt vmcnt(0)
    s_barrier
    s_waitcnt vmcnt(0)
    s_barrier
    s_endpgm
F_compute:
    v_and_b32 v4, 15, v0
    v_lshrrev_b32 v5, 4, v0
    v_lshlrev_b32 v6, 3, v4
    v_lshl_add_u32 v18, v5, 12, v6
    s_lshl_b32 s53, s44, 16
    s_lshl_b32 s50, s45, 7
    s_add_u32 s53, s53, s50
    v_lshlrev_b32 v7, 3, v5
    v_lshl_add_u32 v19, v4, 14, v7
    s_lshl_b32 s54, s45, 18
    s_lshl_b32 s55, s44, 7
    s_add_u32 s54, s54, s55
    s_add_u32 s54, s54, 0x700000
    s_mov_b32 s32, s10
    s_mov_b32 s33, s11
    s_mov_b32 s34, 0x400
    s_mov_b32 s35, 0x00020000
    s_mov_b32 s36, s6
    s_mov_b32 s37, s7
    s_mov_b32 s38, 0x200000
    s_mov_b32 s39, 0x00020000
    s_mov_b32 s56, s12
    s_mov_b32 s57, s13
    s_mov_b32 s58, 0x200000
    s_mov_b32 s59, 0x00020000
    buffer_load_dwordx2 v[24:25], v18, s[36:39], s53 offen offset:0
    buffer_load_dwordx2 v[26:27], v18, s[36:39], s53 offen offset:1024
    buffer_load_dwordx2 v[28:29], v18, s[36:39], s53 offen offset:2048
    buffer_load_dwordx2 v[30:31], v18, s[36:39], s53 offen offset:3072
    buffer_load_dwordx2 v[10:11], v6, s[32:35], s50 offen
    v_and_b32 v4, 31, v1
    v_lshrrev_b32 v5, 5, v1
    v_lshl_add_u32 v6, v2, 1, v5
    v_bfe_u32 v7, v1, 1, 3
    v_xor_b32 v8, v6, v7
    v_lshlrev_b32 v8, 4, v8
    v_lshl_add_u32 v12, v4, 7, v8
    v_bfe_u32 v4, v1, 2, 2
    v_lshl_add_u32 v6, v5, 3, v4
    v_lshl_add_u32 v6, v2, 4, v6
    v_lshlrev_b32 v6, 7, v6
    v_bfe_u32 v7, v1, 4, 1
    v_lshl_add_u32 v6, v7, 5, v6
    v_and_b32 v7, 3, v1
    v_lshl_add_u32 v6, v7, 3, v6
    v_add_u32 v6, 8192, v6
    v_lshrrev_b32 v7, 1, v4
    v_lshl_add_u32 v13, v7, 6, v6
    v_xor_b32 v14, 64, v13
    v_mov_b64 v[64:65], 0
    v_mov_b64 v[66:67], 0
    v_mov_b64 v[68:69], 0
    v_mov_b64 v[70:71], 0
    v_mov_b64 v[72:73], 0
    v_mov_b64 v[74:75], 0
    v_mov_b64 v[76:77], 0
    v_mov_b64 v[78:79], 0
    v_mov_b64 v[80:81], 0
    v_mov_b64 v[82:83], 0
    v_mov_b64 v[84:85], 0
    v_mov_b64 v[86:87], 0
    v_mov_b64 v[88:89], 0
    v_mov_b64 v[90:91], 0
    v_mov_b64 v[92:93], 0
    v_mov_b64 v[94:95], 0
    v_mov_b64 v[96:97], 0
    v_mov_b64 v[98:99], 0
    v_mov_b64 v[100:101], 0
    v_mov_b64 v[102:103], 0
    v_mov_b64 v[104:105], 0
    v_mov_b64 v[106:107], 0
    v_mov_b64 v[108:109], 0
    v_mov_b64 v[110:111], 0
    v_mov_b64 v[112:113], 0
    v_mov_b64 v[114:115], 0
    v_mov_b64 v[116:117], 0
    v_mov_b64 v[118:119], 0
    v_mov_b64 v[120:121], 0
    v_mov_b64 v[122:123], 0
    v_mov_b64 v[124:125], 0
    v_mov_b64 v[126:127], 0
    v_and_b32 v4, 31, v1
    v_mul_u32_u24 v6, 528, v5
    v_lshl_add_u32 v4, v4, 4, v6
    v_mul_u32_u24 v6, 16896, v2
    v_add_u32 v16, v4, v6
    v_bfe_u32 v5, v0, 3, 1
    v_lshrrev_b32 v6, 7, v0
    v_lshl_add_u32 v5, v5, 1, v6
    v_bfe_u32 v6, v0, 1, 2
    v_lshl_add_u32 v5, v5, 2, v6
    v_mul_u32_u24 v5, 1056, v5
    v_and_b32 v6, 1, v0
    v_mul_u32_u24 v6, 528, v6
    v_add_u32 v5, v5, v6
    v_bfe_u32 v6, v0, 4, 3
    v_lshl_add_u32 v17, v6, 6, v5
    s_mov_b32 s60, 0
    s_mov_b32 s65, 0
    s_cmp_lg_u32 s46, 0
    s_cbranch_scc1 FL_go
    s_lshr_b32 s61, s44, 1
    s_lshl_b32 s61, s61, 8
    s_add_u32 s61, s61, 0x6a0100
    v_mov_b32 v4, 0
    s_mov_b32 s86, 0
FL_poll:
    buffer_load_dword v5, v4, s[24:27], s61 offen sc1
    s_waitcnt vmcnt(0)
    v_readfirstlane_b32 s62, v5
    s_nop 0
    s_cmp_ge_u32 s62, 14
    s_cbranch_scc1 FL_go
    s_sleep 16
    s_add_u32 s86, s86, 1
    s_cmp_lt_u32 s86, 0x40000
    s_cbranch_scc1 FL_poll
FL_go:
    s_barrier
    s_setprio 2
    v_mov_b32 v9, 0
    s_lshl_b32 s63, s45, 8
    s_add_u32 s63, s63, 0x6a2800
    s_barrier
    v_add_u32 v20, s60, v12
    v_add_u32 v21, s60, v13
    v_add_u32 v22, s60, v14
    s_add_u32 s60, s60, 16384
    s_cmp_eq_u32 s60, 81920
    s_cselect_b32 s60, 0, s60
    ds_read_b128 v[32:35], v20 offset:0
    ds_read_b128 v[36:39], v20 offset:4096
    ds_read_b64_tr_b16 v[40:41], v21 offset:0
    ds_read_b64_tr_b16 v[42:43], v21 offset:512
    ds_read_b64_tr_b16 v[44:45], v22 offset:0
    ds_read_b64_tr_b16 v[46:47], v22 offset:512
FC_loop:
    s_barrier
    v_add_u32 v20, s60, v12
    v_add_u32 v21, s60, v13
    v_add_u32 v22, s60, v14
    s_add_u32 s60, s60, 16384
    s_cmp_eq_u32 s60, 81920
    s_cselect_b32 s60, 0, s60
    ds_read_b128 v[48:51], v20 offset:0
    ds_read_b128 v[52:55], v20 offset:4096
    ds_read_b64_tr_b16 v[56:57], v21 offset:0
    ds_read_b64_tr_b16 v[58:59], v21 offset:512
    ds_read_b64_tr_b16 v[60:61], v22 offset:0
    ds_read_b64_tr_b16 v[62:63], v22 offset:512
    s_waitcnt lgkmcnt(6)
    v_mfma_f32_32x32x16_bf16 v[64:79], v[40:43], v[32:35], v[64:79]
    v_mfma_f32_32x32x16_bf16 v[80:95], v[40:43], v[36:39], v[80:95]
    v_mfma_f32_32x32x16_bf16 v[96:111], v[44:47], v[32:35], v[96:111]
    v_mfma_f32_32x32x16_bf16 v[112:127], v[44:47], v[36:39], v[112:127]
    s_barrier
    v_add_u32 v20, s60, v12
    v_add_u32 v21, s60, v13
    v_add_u32 v22, s60, v14
    s_add_u32 s60, s60, 16384
    s_cmp_eq_u32 s60, 81920
    s_cselect_b32 s60, 0, s60
    ds_read_b128 v[32:35], v20 offset:0
    ds_read_b128 v[36:39], v20 offset:4096
    ds_read_b64_tr_b16 v[40:41], v21 offset:0
    ds_read_b64_tr_b16 v[42:43], v21 offset:512
    ds_read_b64_tr_b16 v[44:45], v22 offset:0
    ds_read_b64_tr_b16 v[46:47], v22 offset:512
    s_waitcnt lgkmcnt(6)
    v_mfma_f32_32x32x16_bf16 v[64:79], v[56:59], v[48:51], v[64:79]
    v_mfma_f32_32x32x16_bf16 v[80:95], v[56:59], v[52:55], v[80:95]
    v_mfma_f32_32x32x16_bf16 v[96:111], v[60:63], v[48:51], v[96:111]
    v_mfma_f32_32x32x16_bf16 v[112:127], v[60:63], v[52:55], v[112:127]
    s_add_u32 s65, s65, 1
    s_lshl_b32 s62, s46, 8
    s_add_u32 s62, s62, s65
    s_cmp_lg_u32 s62, 12
    s_cbranch_scc1 FC_nolook
    buffer_load_dword v9, v9, s[24:27], s63 offen sc1
FC_nolook:
    s_cmp_lt_u32 s65, 14
    s_cbranch_scc1 FC_loop
    s_waitcnt lgkmcnt(0)
    s_setprio 0
    s_cmp_lg_u32 s46, 0
    s_cbranch_scc1 FC_go
    s_waitcnt vmcnt(0)
    v_readfirstlane_b32 s60, v9
    s_nop 0
    s_cmp_ge_u32 s60, 32
    s_cbranch_scc1 FC_go
    v_mov_b32 v4, 0
    s_lshl_b32 s61, s45, 8
    s_add_u32 s61, s61, 0x6a2800
    s_mov_b32 s86, 0
FC_poll:
    buffer_load_dword v5, v4, s[24:27], s61 offen sc1
    s_waitcnt vmcnt(0)
    v_readfirstlane_b32 s60, v5
    s_nop 0
    s_cmp_ge_u32 s60, 32
    s_cbranch_scc1 FC_go
    s_sleep 24
    s_add_u32 s86, s86, 1
    s_cmp_lt_u32 s86, 0x40000
    s_cbranch_scc1 FC_poll
FC_go:
    s_barrier
    s_add_u32 s55, s54, 8192
    v_add_u32 v7, 4096, v19
    buffer_load_dwordx2 v[40:41], v19, s[24:27], s54 offen sc1
    buffer_load_dwordx2 v[42:43], v7, s[24:27], s54 offen sc1
    buffer_load_dwordx2 v[44:45], v19, s[24:27], s55 offen sc1
    buffer_load_dwordx2 v[46:47], v7, s[24:27], s55 offen sc1
    s_nop 15
    s_nop 15
    s_nop 15
    ds_write_b128 v16, v[64:67] offset:0
    ds_write_b128 v16, v[68:71] offset:1056
    ds_write_b128 v16, v[72:75] offset:2112
    ds_write_b128 v16, v[76:79] offset:3168
    ds_write_b128 v16, v[80:83] offset:4224
    ds_write_b128 v16, v[84:87] offset:5280
    ds_write_b128 v16, v[88:91] offset:6336
    ds_write_b128 v16, v[92:95] offset:7392
    ds_write_b128 v16, v[96:99] offset:8448
    ds_write_b128 v16, v[100:103] offset:9504
    ds_write_b128 v16, v[104:107] offset:10560
    ds_write_b128 v16, v[108:111] offset:11616
    ds_write_b128 v16, v[112:115] offset:12672
    ds_write_b128 v16, v[116:119] offset:13728
    ds_write_b128 v16, v[120:123] offset:14784
    ds_write_b128 v16, v[124:127] offset:15840
    v_lshlrev_b32 v20, 16, v10
    v_and_b32 v21, s64, v10
    v_lshlrev_b32 v22, 16, v11
    v_and_b32 v23, s64, v11
    s_waitcnt lgkmcnt(0)
    s_barrier
    ds_read_b128 v[64:67], v17 offset:0
    ds_read_b128 v[68:71], v17 offset:16
    ds_read_b128 v[72:75], v17 offset:32
    ds_read_b128 v[76:79], v17 offset:48
    ds_read_b128 v[80:83], v17 offset:16896
    ds_read_b128 v[84:87], v17 offset:16912
    ds_read_b128 v[88:91], v17 offset:16928
    ds_read_b128 v[92:95], v17 offset:16944
    ds_read_b128 v[96:99], v17 offset:33792
    ds_read_b128 v[100:103], v17 offset:33808
    ds_read_b128 v[104:107], v17 offset:33824
    ds_read_b128 v[108:111], v17 offset:33840
    ds_read_b128 v[112:115], v17 offset:50688
    ds_read_b128 v[116:119], v17 offset:50704
    ds_read_b128 v[120:123], v17 offset:50720
    ds_read_b128 v[124:127], v17 offset:50736
    s_waitcnt vmcnt(0)
    v_lshlrev_b32 v48, 16, v40
    v_and_b32 v52, s64, v40
    v_lshlrev_b32 v56, 16, v41
    v_and_b32 v60, s64, v41
    v_lshlrev_b32 v49, 16, v42
    v_and_b32 v53, s64, v42
    v_lshlrev_b32 v57, 16, v43
    v_and_b32 v61, s64, v43
    v_lshlrev_b32 v50, 16, v44
    v_and_b32 v54, s64, v44
    v_lshlrev_b32 v58, 16, v45
    v_and_b32 v62, s64, v45
    v_lshlrev_b32 v51, 16, v46
    v_and_b32 v55, s64, v46
    v_lshlrev_b32 v59, 16, v47
    v_and_b32 v63, s64, v47
    v_lshlrev_b32 v32, 16, v24
    v_and_b32 v33, s64, v24
    v_lshlrev_b32 v34, 16, v25
    v_and_b32 v35, s64, v25
    v_lshlrev_b32 v36, 16, v26
    v_and_b32 v37, s64, v26
    v_lshlrev_b32 v38, 16, v27
    v_and_b32 v39, s64, v27
    v_lshlrev_b32 v40, 16, v28
    v_and_b32 v41, s64, v28
    v_lshlrev_b32 v42, 16, v29
    v_and_b32 v43, s64, v29
    v_lshlrev_b32 v44, 16, v30
    v_and_b32 v45, s64, v30
    v_lshlrev_b32 v46, 16, v31
    v_and_b32 v47, s64, v31
    s_waitcnt lgkmcnt(8)
    v_pk_add_f32 v[64:65], v[64:65], v[80:81]
    v_pk_add_f32 v[66:67], v[66:67], v[82:83]
    v_pk_add_f32 v[68:69], v[68:69], v[84:85]
    v_pk_add_f32 v[70:71], v[70:71], v[86:87]
    v_pk_add_f32 v[72:73], v[72:73], v[88:89]
    v_pk_add_f32 v[74:75], v[74:75], v[90:91]
    v_pk_add_f32 v[76:77], v[76:77], v[92:93]
    v_pk_add_f32 v[78:79], v[78:79], v[94:95]
    s_waitcnt lgkmcnt(0)
    v_pk_add_f32 v[96:97], v[96:97], v[112:113]
    v_pk_add_f32 v[98:99], v[98:99], v[114:115]
    v_pk_add_f32 v[100:101], v[100:101], v[116:117]
    v_pk_add_f32 v[102:103], v[102:103], v[118:119]
    v_pk_add_f32 v[104:105], v[104:105], v[120:121]
    v_pk_add_f32 v[106:107], v[106:107], v[122:123]
    v_pk_add_f32 v[108:109], v[108:109], v[124:125]
    v_pk_add_f32 v[110:111], v[110:111], v[126:127]
    v_pk_add_f32 v[64:65], v[64:65], v[96:97]
    v_pk_add_f32 v[66:67], v[66:67], v[98:99]
    v_pk_add_f32 v[68:69], v[68:69], v[100:101]
    v_pk_add_f32 v[70:71], v[70:71], v[102:103]
    v_pk_add_f32 v[72:73], v[72:73], v[104:105]
    v_pk_add_f32 v[74:75], v[74:75], v[106:107]
    v_pk_add_f32 v[76:77], v[76:77], v[108:109]
    v_pk_add_f32 v[78:79], v[78:79], v[110:111]
    v_cvt_pk_bf16_f32 v80, v64, v65
    v_cvt_pk_bf16_f32 v81, v66, v67
    v_cvt_pk_bf16_f32 v82, v68, v69
    v_cvt_pk_bf16_f32 v83, v70, v71
    v_cvt_pk_bf16_f32 v84, v72, v73
    v_cvt_pk_bf16_f32 v85, v74, v75
    v_cvt_pk_bf16_f32 v86, v76, v77
    v_cvt_pk_bf16_f32 v87, v78, v79
    v_lshlrev_b32 v64, 16, v80
    v_and_b32 v65, s64, v80
    v_lshlrev_b32 v66, 16, v81
    v_and_b32 v67, s64, v81
    v_lshlrev_b32 v68, 16, v82
    v_and_b32 v69, s64, v82
    v_lshlrev_b32 v70, 16, v83
    v_and_b32 v71, s64, v83
    v_lshlrev_b32 v72, 16, v84
    v_and_b32 v73, s64, v84
    v_lshlrev_b32 v74, 16, v85
    v_and_b32 v75, s64, v85
    v_lshlrev_b32 v76, 16, v86
    v_and_b32 v77, s64, v86
    v_lshlrev_b32 v78, 16, v87
    v_and_b32 v79, s64, v87
    v_pk_add_f32 v[64:65], v[64:65], v[20:21]
    v_pk_add_f32 v[66:67], v[66:67], v[22:23]
    v_pk_add_f32 v[68:69], v[68:69], v[20:21]
    v_pk_add_f32 v[70:71], v[70:71], v[22:23]
    v_pk_add_f32 v[72:73], v[72:73], v[20:21]
    v_pk_add_f32 v[74:75], v[74:75], v[22:23]
    v_pk_add_f32 v[76:77], v[76:77], v[20:21]
    v_pk_add_f32 v[78:79], v[78:79], v[22:23]
    v_cvt_pk_bf16_f32 v80, v64, v65
    v_cvt_pk_bf16_f32 v81, v66, v67
    v_cvt_pk_bf16_f32 v82, v68, v69
    v_cvt_pk_bf16_f32 v83, v70, v71
    v_cvt_pk_bf16_f32 v84, v72, v73
    v_cvt_pk_bf16_f32 v85, v74, v75
    v_cvt_pk_bf16_f32 v86, v76, v77
    v_cvt_pk_bf16_f32 v87, v78, v79
    v_lshlrev_b32 v64, 16, v80
    v_and_b32 v65, s64, v80
    v_lshlrev_b32 v66, 16, v81
    v_and_b32 v67, s64, v81
    v_lshlrev_b32 v68, 16, v82
    v_and_b32 v69, s64, v82
    v_lshlrev_b32 v70, 16, v83
    v_and_b32 v71, s64, v83
    v_lshlrev_b32 v72, 16, v84
    v_and_b32 v73, s64, v84
    v_lshlrev_b32 v74, 16, v85
    v_and_b32 v75, s64, v85
    v_lshlrev_b32 v76, 16, v86
    v_and_b32 v77, s64, v86
    v_lshlrev_b32 v78, 16, v87
    v_and_b32 v79, s64, v87
    s_mov_b32 s60, 0xbfb8aa3b
    v_pk_mul_f32 v[96:97], v[64:65], s[60:61] op_sel_hi:[1,0]
    v_pk_mul_f32 v[98:99], v[66:67], s[60:61] op_sel_hi:[1,0]
    v_pk_mul_f32 v[100:101], v[68:69], s[60:61] op_sel_hi:[1,0]
    v_pk_mul_f32 v[102:103], v[70:71], s[60:61] op_sel_hi:[1,0]
    v_pk_mul_f32 v[104:105], v[72:73], s[60:61] op_sel_hi:[1,0]
    v_pk_mul_f32 v[106:107], v[74:75], s[60:61] op_sel_hi:[1,0]
    v_pk_mul_f32 v[108:109], v[76:77], s[60:61] op_sel_hi:[1,0]
    v_pk_mul_f32 v[110:111], v[78:79], s[60:61] op_sel_hi:[1,0]
    v_exp_f32 v96, v96
    v_exp_f32 v97, v97
    v_exp_f32 v98, v98
    v_exp_f32 v99, v99
    v_exp_f32 v100, v100
    v_exp_f32 v101, v101
    v_exp_f32 v102, v102
    v_exp_f32 v103, v103
    v_exp_f32 v104, v104
    v_exp_f32 v105, v105
    v_exp_f32 v106, v106
    v_exp_f32 v107, v107
    v_exp_f32 v108, v108
    v_exp_f32 v109, v109
    v_exp_f32 v110, v110
    v_exp_f32 v111, v111
    v_pk_add_f32 v[96:97], v[96:97], 1.0 op_sel_hi:[1,0]
    v_pk_add_f32 v[98:99], v[98:99], 1.0 op_sel_hi:[1,0]
    v_pk_add_f32 v[100:101], v[100:101], 1.0 op_sel_hi:[1,0]
    v_pk_add_f32 v[102:103], v[102:103], 1.0 op_sel_hi:[1,0]
    v_pk_add_f32 v[104:105], v[104:105], 1.0 op_sel_hi:[1,0]
    v_pk_add_f32 v[106:107], v[106:107], 1.0 op_sel_hi:[1,0]
    v_pk_add_f32 v[108:109], v[108:109], 1.0 op_sel_hi:[1,0]
    v_pk_add_f32 v[110:111], v[110:111], 1.0 op_sel_hi:[1,0]
    v_rcp_f32 v96, v96
    v_rcp_f32 v97, v97
    v_rcp_f32 v98, v98
    v_rcp_f32 v99, v99
    v_rcp_f32 v100, v100
    v_rcp_f32 v101, v101
    v_rcp_f32 v102, v102
    v_rcp_f32 v103, v103
    v_rcp_f32 v104, v104
    v_rcp_f32 v105, v105
    v_rcp_f32 v106, v106
    v_rcp_f32 v107, v107
    v_rcp_f32 v108, v108
    v_rcp_f32 v109, v109
    v_rcp_f32 v110, v110
    v_rcp_f32 v111, v111
    v_pk_mul_f32 v[64:65], v[64:65], v[96:97]
    v_pk_mul_f32 v[66:67], v[66:67], v[98:99]
    v_pk_mul_f32 v[68:69], v[68:69], v[100:101]
    v_pk_mul_f32 v[70:71], v[70:71], v[102:103]
    v_pk_mul_f32 v[72:73], v[72:73], v[104:105]
    v_pk_mul_f32 v[74:75], v[74:75], v[106:107]
    v_pk_mul_f32 v[76:77], v[76:77], v[108:109]
    v_pk_mul_f32 v[78:79], v[78:79], v[110:111]
    v_cvt_pk_bf16_f32 v80, v64, v65
    v_cvt_pk_bf16_f32 v81, v66, v67
    v_cvt_pk_bf16_f32 v82, v68, v69
    v_cvt_pk_bf16_f32 v83, v70, v71
    v_cvt_pk_bf16_f32 v84, v72, v73
    v_cvt_pk_bf16_f32 v85, v74, v75
    v_cvt_pk_bf16_f32 v86, v76, v77
    v_cvt_pk_bf16_f32 v87, v78, v79
    v_lshlrev_b32 v64, 16, v80
    v_and_b32 v65, s64, v80
    v_lshlrev_b32 v66, 16, v81
    v_and_b32 v67, s64, v81
    v_lshlrev_b32 v68, 16, v82
    v_and_b32 v69, s64, v82
    v_lshlrev_b32 v70, 16, v83
    v_and_b32 v71, s64, v83
    v_lshlrev_b32 v72, 16, v84
    v_and_b32 v73, s64, v84
    v_lshlrev_b32 v74, 16, v85
    v_and_b32 v75, s64, v85
    v_lshlrev_b32 v76, 16, v86
    v_and_b32 v77, s64, v86
    v_lshlrev_b32 v78, 16, v87
    v_and_b32 v79, s64, v87
    v_pk_mul_f32 v[64:65], v[64:65], v[48:49]
    v_pk_mul_f32 v[66:67], v[66:67], v[50:51]
    v_pk_mul_f32 v[68:69], v[68:69], v[52:53]
    v_pk_mul_f32 v[70:71], v[70:71], v[54:55]
    v_pk_mul_f32 v[72:73], v[72:73], v[56:57]
    v_pk_mul_f32 v[74:75], v[74:75], v[58:59]
    v_pk_mul_f32 v[76:77], v[76:77], v[60:61]
    v_pk_mul_f32 v[78:79], v[78:79], v[62:63]
    v_cvt_pk_bf16_f32 v80, v64, v65
    v_cvt_pk_bf16_f32 v81, v66, v67
    v_cvt_pk_bf16_f32 v82, v68, v69
    v_cvt_pk_bf16_f32 v83, v70, v71
    v_cvt_pk_bf16_f32 v84, v72, v73
    v_cvt_pk_bf16_f32 v85, v74, v75
    v_cvt_pk_bf16_f32 v86, v76, v77
    v_cvt_pk_bf16_f32 v87, v78, v79
    v_lshlrev_b32 v64, 16, v80
    v_and_b32 v65, s64, v80
    v_lshlrev_b32 v66, 16, v81
    v_and_b32 v67, s64, v81
    v_lshlrev_b32 v68, 16, v82
    v_and_b32 v69, s64, v82
    v_lshlrev_b32 v70, 16, v83
    v_and_b32 v71, s64, v83
    v_lshlrev_b32 v72, 16, v84
    v_and_b32 v73, s64, v84
    v_lshlrev_b32 v74, 16, v85
    v_and_b32 v75, s64, v85
    v_lshlrev_b32 v76, 16, v86
    v_and_b32 v77, s64, v86
    v_lshlrev_b32 v78, 16, v87
    v_and_b32 v79, s64, v87
    v_pk_add_f32 v[64:65], v[64:65], v[32:33]
    v_pk_add_f32 v[66:67], v[66:67], v[34:35]
    v_pk_add_f32 v[68:69], v[68:69], v[36:37]
    v_pk_add_f32 v[70:71], v[70:71], v[38:39]
    v_pk_add_f32 v[72:73], v[72:73], v[40:41]
    v_pk_add_f32 v[74:75], v[74:75], v[42:43]
    v_pk_add_f32 v[76:77], v[76:77], v[44:45]
    v_pk_add_f32 v[78:79], v[78:79], v[46:47]
    v_cvt_pk_bf16_f32 v80, v64, v65
    v_cvt_pk_bf16_f32 v81, v66, v67
    v_cvt_pk_bf16_f32 v82, v68, v69
    v_cvt_pk_bf16_f32 v83, v70, v71
    v_cvt_pk_bf16_f32 v84, v72, v73
    v_cvt_pk_bf16_f32 v85, v74, v75
    v_cvt_pk_bf16_f32 v86, v76, v77
    v_cvt_pk_bf16_f32 v87, v78, v79
    buffer_store_dwordx2 v[80:81], v18, s[56:59], s53 offen offset:0 sc1
    buffer_store_dwordx2 v[82:83], v18, s[56:59], s53 offen offset:1024 sc1
    buffer_store_dwordx2 v[84:85], v18, s[56:59], s53 offen offset:2048 sc1
    buffer_store_dwordx2 v[86:87], v18, s[56:59], s53 offen offset:3072 sc1
    s_endpgm
F_conv:
    s_setprio 0
    s_lshr_b32 s47, s46, 2
    s_and_b32 s46, s46, 3
    v_and_b32 v0, 255, v0
    v_and_b32 v2, 3, v2
    s_sub_u32 s3, s2, 256
    s_lshl_b32 s3, s3, 1
    s_add_u32 s3, s3, s47
    s_waitcnt lgkmcnt(0)
    s_mov_b32 s24, s4
    s_mov_b32 s25, s5
    s_mov_b32 s26, 0x1400000
    s_mov_b32 s27, 0x00020000
    s_mov_b32 s68, s16
    s_mov_b32 s69, s17
    s_mov_b32 s70, 0x100
    s_mov_b32 s71, 0x00020000
    s_lshl_b32 s45, s47, 14
    s_mov_b32 s28, s76
    s_mov_b32 s29, s77
    s_mov_b32 s30, 0x20000
    s_mov_b32 s31, 0x00020000
    s_mov_b32 s32, s78
    s_mov_b32 s33, s79
    s_mov_b32 s34, 0x20000
    s_mov_b32 s35, 0x00020000
    s_mov_b32 s36, s80
    s_mov_b32 s37, s81
    s_mov_b32 s38, 0x20000
    s_mov_b32 s39, 0x00020000
    s_mov_b32 s40, s82
    s_mov_b32 s41, s83
    s_mov_b32 s42, 0x20000
    s_mov_b32 s43, 0x00020000
    s_mov_b32 s48, s84
    s_mov_b32 s49, s85
    s_mov_b32 s50, 0x400
    s_mov_b32 s51, 0x00020000
    s_lshl_b32 s8, s3, 8
    s_lshl_b32 s9, s3, 1
    v_mov_b32 v5, 0
    buffer_load_ushort v96, v5, s[48:51], s9 offen
    v_lshlrev_b32 v4, 2, v1
    buffer_load_dword v98, v4, s[36:39], s8 offen
    buffer_load_dword v99, v4, s[40:43], s8 offen
    v_lshrrev_b32 v3, 4, v1
    v_lshlrev_b32 v6, 3, v3
    v_lshl_add_u32 v6, v2, 6, v6
    buffer_load_dwordx2 v[64:65], v6, s[28:31], s8 offen offset:0
    buffer_load_dwordx2 v[66:67], v6, s[32:35], s8 offen offset:0
    buffer_load_dwordx2 v[68:69], v6, s[36:39], s8 offen offset:0
    buffer_load_dwordx2 v[70:71], v6, s[40:43], s8 offen offset:0
    buffer_load_dwordx2 v[72:73], v6, s[28:31], s8 offen offset:32
    buffer_load_dwordx2 v[74:75], v6, s[32:35], s8 offen offset:32
    buffer_load_dwordx2 v[76:77], v6, s[36:39], s8 offen offset:32
    buffer_load_dwordx2 v[78:79], v6, s[40:43], s8 offen offset:32
    s_mov_b32 s60, 0x3fb8aa3b
    s_mov_b32 s62, 0x32a57060
    s_mov_b32 s66, 0x3f317218
    v_and_b32 v4, 15, v1
    v_lshlrev_b32 v8, 4, v4
    v_mov_b32 v9, v4
    v_lshlrev_b32 v10, 1, v4
    v_add_u32 v10, 256, v10
    v_bfe_u32 v32, v4, 2, 1
    v_lshlrev_b32 v32, 8, v32
    v_and_b32 v33, 3, v4
    v_lshl_add_u32 v32, v33, 2, v32
    v_add_u32 v32, 512, v32
    v_cmp_gt_u32 vcc, 8, v4
    s_nop 1
    v_cndmask_b32 v10, v32, v10, vcc
    v_lshrrev_b32 v32, 1, v4
    v_lshlrev_b32 v32, 8, v32
    v_and_b32 v33, 1, v4
    v_lshl_add_u32 v32, v33, 3, v32
    v_add_u32 v11, 1024, v32
    v_mov_b32 v33, 2304
    v_cmp_gt_u32 vcc, 9, v4
    s_nop 1
    v_cndmask_b32 v11, v33, v11, vcc
    v_cvt_f32_u32 v8, v8
    v_cvt_f32_u32 v9, v9
    v_cvt_f32_u32 v10, v10
    v_cvt_f32_u32 v11, v11
    v_mov_b32 v30, v11
    v_mov_b32 v28, v10
    v_mul_u32_u24 v32, 2816, v2
    v_add_u32 v32, s45, v32
    v_lshl_add_u32 v12, v4, 2, v32
    v_lshl_add_u32 v12, v3, 8, v12
    v_mov_b32 v15, 64
    v_lshrrev_b32 v33, 16, v10
    v_subrev_u32 v33, 0x4280, v33
    v_lshrrev_b32 v34, 23, v10
    v_subrev_u32 v34, 134, v34
    v_lshrrev_b32 v16, v34, v15
    v_mul_u32_u24 v35, v16, v3
    v_lshl_add_u32 v35, v35, 2, v32
    v_lshl_add_u32 v13, v33, 2, v35
    v_lshrrev_b32 v33, 16, v11
    v_subrev_u32 v33, 0x4280, v33
    v_lshrrev_b32 v34, 23, v11
    v_subrev_u32 v34, 134, v34
    v_lshrrev_b32 v17, v34, v15
    v_mul_u32_u24 v35, v17, v3
    v_lshl_add_u32 v35, v35, 2, v32
    v_lshl_add_u32 v14, v33, 2, v35
    v_mov_b32 v10, v9
    v_mov_b64 v[116:117], 0
    v_mov_b64 v[118:119], 0
    v_mov_b64 v[120:121], 0
    v_mov_b64 v[122:123], 0
    v_mov_b64 v[124:125], 0
    v_mov_b64 v[126:127], 0
    v_lshlrev_b32 v32, 3, v0
    v_sub_u32 v32, 2047, v32
    v_subrev_u32 v18, 0, v32
    v_subrev_u32 v19, 1, v32
    v_subrev_u32 v20, 2, v32
    v_subrev_u32 v21, 3, v32
    v_subrev_u32 v22, 4, v32
    v_subrev_u32 v23, 5, v32
    v_subrev_u32 v24, 6, v32
    v_subrev_u32 v25, 7, v32
    v_subrev_u32 v26, 8, v32
    v_max_i32 v26, 0, v26
    v_cvt_f32_u32 v32, v18
    v_cvt_f32_u32 v33, v19
    v_cvt_f32_u32 v34, v20
    v_cvt_f32_u32 v35, v21
    v_cvt_f32_u32 v36, v22
    v_cvt_f32_u32 v37, v23
    v_cvt_f32_u32 v38, v24
    v_cvt_f32_u32 v39, v25
    v_cvt_f32_u32 v40, v26
    v_cvt_pk_bf16_f32 v32, v32, v33
    v_cvt_pk_bf16_f32 v34, v34, v35
    v_cvt_pk_bf16_f32 v36, v36, v37
    v_cvt_pk_bf16_f32 v38, v38, v39
    v_cvt_pk_bf16_f32 v40, v40, v40
    v_lshrrev_b32 v33, 16, v32
    v_and_b32 v32, 0xffff, v32
    v_lshrrev_b32 v35, 16, v34
    v_and_b32 v34, 0xffff, v34
    v_lshrrev_b32 v37, 16, v36
    v_and_b32 v36, 0xffff, v36
    v_lshrrev_b32 v39, 16, v38
    v_and_b32 v38, 0xffff, v38
    v_and_b32 v40, 0xffff, v40
    v_subrev_u32 v32, 0x4280, v32
    v_subrev_u32 v33, 0x4280, v33
    v_subrev_u32 v34, 0x4280, v34
    v_subrev_u32 v35, 0x4280, v35
    v_subrev_u32 v36, 0x4280, v36
    v_subrev_u32 v37, 0x4280, v37
    v_subrev_u32 v38, 0x4280, v38
    v_subrev_u32 v39, 0x4280, v39
    v_subrev_u32 v40, 0x4280, v40
    v_cmp_gt_u32 vcc, 128, v18
    s_nop 1
    v_cndmask_b32 v18, v32, v18, vcc
    v_cmp_gt_u32 vcc, 128, v19
    s_nop 1
    v_cndmask_b32 v19, v33, v19, vcc
    v_cmp_gt_u32 vcc, 128, v20
    s_nop 1
    v_cndmask_b32 v20, v34, v20, vcc
    v_cmp_gt_u32 vcc, 128, v21
    s_nop 1
    v_cndmask_b32 v21, v35, v21, vcc
    v_cmp_gt_u32 vcc, 128, v22
    s_nop 1
    v_cndmask_b32 v22, v36, v22, vcc
    v_cmp_gt_u32 vcc, 128, v23
    s_nop 1
    v_cndmask_b32 v23, v37, v23, vcc
    v_cmp_gt_u32 vcc, 128, v24
    s_nop 1
    v_cndmask_b32 v24, v38, v24, vcc
    v_cmp_gt_u32 vcc, 128, v25
    s_nop 1
    v_cndmask_b32 v25, v39, v25, vcc
    v_cmp_gt_u32 vcc, 128, v26
    s_nop 1
    v_cndmask_b32 v26, v40, v26, vcc
    v_lshl_add_u32 v18, v18, 2, s45
    v_lshl_add_u32 v19, v19, 2, s45
    v_lshl_add_u32 v20, v20, 2, s45
    v_lshl_add_u32 v21, v21, 2, s45
    v_lshl_add_u32 v22, v22, 2, s45
    v_lshl_add_u32 v23, v23, 2, s45
    v_lshl_add_u32 v24, v24, 2, s45
    v_lshl_add_u32 v25, v25, 2, s45
    v_lshl_add_u32 v26, v26, 2, s45
    s_waitcnt vmcnt(10)
    v_lshlrev_b32 v96, 16, v96
    v_mul_f32 v4, s60, v96
    v_fma_f32 v5, v96, s60, -v4
    v_fma_f32 v5, v96, s62, v5
    v_exp_f32 v4, v4
    v_mul_f32 v5, s66, v5
    v_fma_f32 v96, v4, v5, v4
    v_cvt_pk_bf16_f32 v96, v96, v96
    v_and_b32 v96, s64, v96
    s_waitcnt vmcnt(8)
    v_lshlrev_b32 v4, 16, v98
    v_and_b32 v5, s64, v98
    v_lshlrev_b32 v6, 16, v99
    v_and_b32 v7, s64, v99
    v_add_f32 v4, |v4|, |v5|
    v_add_f32 v6, |v6|, |v7|
    v_add_f32 v98, v4, v6
    s_nop 1
    v_add_f32_dpp v98, v98, v98 quad_perm:[1,0,3,2] row_mask:0xf bank_mask:0xf
    s_nop 1
    v_add_f32_dpp v98, v98, v98 quad_perm:[2,3,0,1] row_mask:0xf bank_mask:0xf
    s_nop 1
    v_add_f32_dpp v98, v98, v98 row_half_mirror row_mask:0xf bank_mask:0xf
    s_nop 1
    v_add_f32_dpp v98, v98, v98 row_mirror row_mask:0xf bank_mask:0xf
    v_mov_b32 v99, v98
    s_nop 1
    v_permlane16_swap_b32 v98, v99
    v_add_f32 v98, v98, v99
    v_mov_b32 v99, v98
    s_nop 1
    v_permlane32_swap_b32 v98, v99
    v_add_f32 v98, v98, v99
    v_mul_f32 v98, v98, v96
    v_add_f32 v98, v98, v98
    v_lshrrev_b32 v98, 23, v98
    v_sub_u32 v98, 268, v98
    v_min_u32 v98, 240, v98
    v_sub_u32 v99, 244, v98
    v_lshlrev_b32 v99, 23, v99
    v_lshlrev_b32 v98, 23, v98
    v_mul_f32 v98, v98, v96
    v_add_f32 v98, v98, v98
    v_mul_f32 v4, 0xbfb8aa3b, v96
    v_mul_f32 v5, 0.15915494, v96
    s_waitcnt vmcnt(4)
    v_lshlrev_b32 v48, 16, v64
    v_and_b32 v49, s64, v64
    v_lshlrev_b32 v50, 16, v65
    v_and_b32 v51, s64, v65
    v_pk_mul_f32 v[52:53], v[48:49], s[60:61] op_sel_hi:[1,0]
    v_pk_mul_f32 v[54:55], v[50:51], s[60:61] op_sel_hi:[1,0]
    v_pk_fma_f32 v[56:57], v[48:49], s[60:61], v[52:53] op_sel_hi:[1,0,1] neg_lo:[0,0,1] neg_hi:[0,0,1]
    v_pk_fma_f32 v[58:59], v[50:51], s[60:61], v[54:55] op_sel_hi:[1,0,1] neg_lo:[0,0,1] neg_hi:[0,0,1]
    v_pk_fma_f32 v[56:57], v[48:49], s[62:63], v[56:57] op_sel_hi:[1,0,1]
    v_pk_fma_f32 v[58:59], v[50:51], s[62:63], v[58:59] op_sel_hi:[1,0,1]
    v_exp_f32 v52, v52
    v_exp_f32 v53, v53
    v_exp_f32 v54, v54
    v_exp_f32 v55, v55
    v_pk_mul_f32 v[56:57], v[56:57], s[66:67] op_sel_hi:[1,0]
    v_pk_mul_f32 v[58:59], v[58:59], s[66:67] op_sel_hi:[1,0]
    v_pk_fma_f32 v[52:53], v[52:53], v[56:57], v[52:53]
    v_pk_fma_f32 v[54:55], v[54:55], v[58:59], v[54:55]
    v_cvt_pk_bf16_f32 v48, v52, v53
    v_cvt_pk_bf16_f32 v49, v54, v55
    v_lshlrev_b32 v32, 16, v48
    v_and_b32 v34, s64, v48
    v_lshlrev_b32 v33, 16, v66
    v_and_b32 v35, s64, v66
    v_lshlrev_b32 v40, 16, v68
    v_and_b32 v42, s64, v68
    v_lshlrev_b32 v41, 16, v70
    v_and_b32 v43, s64, v70
    v_lshlrev_b32 v36, 16, v49
    v_and_b32 v38, s64, v49
    v_lshlrev_b32 v37, 16, v67
    v_and_b32 v39, s64, v67
    v_lshlrev_b32 v44, 16, v69
    v_and_b32 v46, s64, v69
    v_lshlrev_b32 v45, 16, v71
    v_and_b32 v47, s64, v71
    v_pk_mul_f32 v[32:33], v[32:33], v[4:5]
    v_pk_mul_f32 v[40:41], v[40:41], v[98:99] op_sel_hi:[1,0]
    v_pk_mul_f32 v[34:35], v[34:35], v[4:5]
    v_pk_mul_f32 v[42:43], v[42:43], v[98:99] op_sel_hi:[1,0]
    v_pk_mul_f32 v[36:37], v[36:37], v[4:5]
    v_pk_mul_f32 v[44:45], v[44:45], v[98:99] op_sel_hi:[1,0]
    v_pk_mul_f32 v[38:39], v[38:39], v[4:5]
    v_pk_mul_f32 v[46:47], v[46:47], v[98:99] op_sel_hi:[1,0]
    v_pk_mul_f32 v[48:49], v[32:33], v[8:9] op_sel_hi:[1,0]
    v_pk_mul_f32 v[50:51], v[34:35], v[8:9] op_sel_hi:[1,0]
    v_pk_mul_f32 v[52:53], v[36:37], v[8:9] op_sel_hi:[1,0]
    v_pk_mul_f32 v[54:55], v[38:39], v[8:9] op_sel_hi:[1,0]
    v_fract_f32 v49, v49
    v_fract_f32 v51, v51
    v_fract_f32 v53, v53
    v_fract_f32 v55, v55
    v_exp_f32 v48, v48
    v_cos_f32 v56, v49
    v_sin_f32 v57, v49
    v_exp_f32 v50, v50
    v_cos_f32 v58, v51
    v_sin_f32 v59, v51
    v_exp_f32 v52, v52
    v_cos_f32 v60, v53
    v_sin_f32 v61, v53
    v_exp_f32 v54, v54
    v_cos_f32 v62, v55
    v_sin_f32 v63, v55
    v_pk_mul_f32 v[56:57], v[56:57], v[48:49] op_sel_hi:[1,0]
    v_pk_mul_f32 v[58:59], v[58:59], v[50:51] op_sel_hi:[1,0]
    v_pk_mul_f32 v[60:61], v[60:61], v[52:53] op_sel_hi:[1,0]
    v_pk_mul_f32 v[62:63], v[62:63], v[54:55] op_sel_hi:[1,0]
    v_pk_mul_f32 v[100:101], v[56:57], v[40:41] op_sel_hi:[1,0] neg_hi:[0,1]
    v_pk_mul_f32 v[102:103], v[58:59], v[42:43] op_sel_hi:[1,0] neg_hi:[0,1]
    v_pk_mul_f32 v[104:105], v[60:61], v[44:45] op_sel_hi:[1,0] neg_hi:[0,1]
    v_pk_mul_f32 v[106:107], v[62:63], v[46:47] op_sel_hi:[1,0] neg_hi:[0,1]
    v_fma_f32 v100, -v41, v57, v100
    v_fma_f32 v101, -v41, v56, v101
    v_fma_f32 v102, -v43, v59, v102
    v_fma_f32 v103, -v43, v58, v103
    v_fma_f32 v104, -v45, v61, v104
    v_fma_f32 v105, -v45, v60, v105
    v_fma_f32 v106, -v47, v63, v106
    v_fma_f32 v107, -v47, v62, v107
    v_cvt_pk_f16_f32 v108, v100, v101
    v_cvt_pk_f16_f32 v109, v102, v103
    v_cvt_pk_f16_f32 v110, v104, v105
    v_cvt_pk_f16_f32 v111, v106, v107
    v_pk_mul_f32 v[48:49], v[32:33], v[10:11] op_sel_hi:[1,0]
    v_pk_mul_f32 v[50:51], v[34:35], v[10:11] op_sel_hi:[1,0]
    v_pk_mul_f32 v[52:53], v[36:37], v[10:11] op_sel_hi:[1,0]
    v_pk_mul_f32 v[54:55], v[38:39], v[10:11] op_sel_hi:[1,0]
    v_fract_f32 v49, v49
    v_fract_f32 v51, v51
    v_fract_f32 v53, v53
    v_fract_f32 v55, v55
    v_exp_f32 v48, v48
    v_cos_f32 v56, v49
    v_sin_f32 v57, v49
    v_exp_f32 v50, v50
    v_cos_f32 v58, v51
    v_sin_f32 v59, v51
    v_exp_f32 v52, v52
    v_cos_f32 v60, v53
    v_sin_f32 v61, v53
    v_exp_f32 v54, v54
    v_cos_f32 v62, v55
    v_sin_f32 v63, v55
    v_pk_mul_f32 v[56:57], v[56:57], v[48:49] op_sel_hi:[1,0]
    v_pk_mul_f32 v[58:59], v[58:59], v[50:51] op_sel_hi:[1,0]
    v_pk_mul_f32 v[60:61], v[60:61], v[52:53] op_sel_hi:[1,0]
    v_pk_mul_f32 v[62:63], v[62:63], v[54:55] op_sel_hi:[1,0]
    v_cvt_pk_f16_f32 v112, v56, v57
    v_cvt_pk_f16_f32 v113, v58, v59
    v_cvt_pk_f16_f32 v114, v60, v61
    v_cvt_pk_f16_f32 v115, v62, v63
    s_nop 5
    v_mfma_f32_16x16x32_f16 v[116:119], v[108:111], v[112:115], v[116:119]
    v_pk_mul_f32 v[48:49], v[32:33], v[28:29] op_sel_hi:[1,0]
    v_pk_mul_f32 v[50:51], v[34:35], v[28:29] op_sel_hi:[1,0]
    v_pk_mul_f32 v[52:53], v[36:37], v[28:29] op_sel_hi:[1,0]
    v_pk_mul_f32 v[54:55], v[38:39], v[28:29] op_sel_hi:[1,0]
    v_fract_f32 v49, v49
    v_fract_f32 v51, v51
    v_fract_f32 v53, v53
    v_fract_f32 v55, v55
    v_exp_f32 v48, v48
    v_cos_f32 v56, v49
    v_sin_f32 v57, v49
    v_exp_f32 v50, v50
    v_cos_f32 v58, v51
    v_sin_f32 v59, v51
    v_exp_f32 v52, v52
    v_cos_f32 v60, v53
    v_sin_f32 v61, v53
    v_exp_f32 v54, v54
    v_cos_f32 v62, v55
    v_sin_f32 v63, v55
    v_pk_mul_f32 v[56:57], v[56:57], v[48:49] op_sel_hi:[1,0]
    v_pk_mul_f32 v[58:59], v[58:59], v[50:51] op_sel_hi:[1,0]
    v_pk_mul_f32 v[60:61], v[60:61], v[52:53] op_sel_hi:[1,0]
    v_pk_mul_f32 v[62:63], v[62:63], v[54:55] op_sel_hi:[1,0]
    v_cvt_pk_f16_f32 v112, v56, v57
    v_cvt_pk_f16_f32 v113, v58, v59
    v_cvt_pk_f16_f32 v114, v60, v61
    v_cvt_pk_f16_f32 v115, v62, v63
    s_nop 5
    v_mfma_f32_16x16x32_f16 v[120:123], v[108:111], v[112:115], v[120:123]
    v_pk_mul_f32 v[48:49], v[32:33], v[30:31] op_sel_hi:[1,0]
    v_pk_mul_f32 v[50:51], v[34:35], v[30:31] op_sel_hi:[1,0]
    v_pk_mul_f32 v[52:53], v[36:37], v[30:31] op_sel_hi:[1,0]
    v_pk_mul_f32 v[54:55], v[38:39], v[30:31] op_sel_hi:[1,0]
    v_fract_f32 v49, v49
    v_fract_f32 v51, v51
    v_fract_f32 v53, v53
    v_fract_f32 v55, v55
    v_exp_f32 v48, v48
    v_cos_f32 v56, v49
    v_sin_f32 v57, v49
    v_exp_f32 v50, v50
    v_cos_f32 v58, v51
    v_sin_f32 v59, v51
    v_exp_f32 v52, v52
    v_cos_f32 v60, v53
    v_sin_f32 v61, v53
    v_exp_f32 v54, v54
    v_cos_f32 v62, v55
    v_sin_f32 v63, v55
    v_pk_mul_f32 v[56:57], v[56:57], v[48:49] op_sel_hi:[1,0]
    v_pk_mul_f32 v[58:59], v[58:59], v[50:51] op_sel_hi:[1,0]
    v_pk_mul_f32 v[60:61], v[60:61], v[52:53] op_sel_hi:[1,0]
    v_pk_mul_f32 v[62:63], v[62:63], v[54:55] op_sel_hi:[1,0]
    v_cvt_pk_f16_f32 v112, v56, v57
    v_cvt_pk_f16_f32 v113, v58, v59
    v_cvt_pk_f16_f32 v114, v60, v61
    v_cvt_pk_f16_f32 v115, v62, v63
    s_nop 5
    v_mfma_f32_16x16x32_f16 v[124:127], v[108:111], v[112:115], v[124:127]
    s_waitcnt vmcnt(0)
    v_lshlrev_b32 v48, 16, v72
    v_and_b32 v49, s64, v72
    v_lshlrev_b32 v50, 16, v73
    v_and_b32 v51, s64, v73
    v_pk_mul_f32 v[52:53], v[48:49], s[60:61] op_sel_hi:[1,0]
    v_pk_mul_f32 v[54:55], v[50:51], s[60:61] op_sel_hi:[1,0]
    v_pk_fma_f32 v[56:57], v[48:49], s[60:61], v[52:53] op_sel_hi:[1,0,1] neg_lo:[0,0,1] neg_hi:[0,0,1]
    v_pk_fma_f32 v[58:59], v[50:51], s[60:61], v[54:55] op_sel_hi:[1,0,1] neg_lo:[0,0,1] neg_hi:[0,0,1]
    v_pk_fma_f32 v[56:57], v[48:49], s[62:63], v[56:57] op_sel_hi:[1,0,1]
    v_pk_fma_f32 v[58:59], v[50:51], s[62:63], v[58:59] op_sel_hi:[1,0,1]
    v_exp_f32 v52, v52
    v_exp_f32 v53, v53
    v_exp_f32 v54, v54
    v_exp_f32 v55, v55
    v_pk_mul_f32 v[56:57], v[56:57], s[66:67] op_sel_hi:[1,0]
    v_pk_mul_f32 v[58:59], v[58:59], s[66:67] op_sel_hi:[1,0]
    v_pk_fma_f32 v[52:53], v[52:53], v[56:57], v[52:53]
    v_pk_fma_f32 v[54:55], v[54:55], v[58:59], v[54:55]
    v_cvt_pk_bf16_f32 v48, v52, v53
    v_cvt_pk_bf16_f32 v49, v54, v55
    v_lshlrev_b32 v32, 16, v48
    v_and_b32 v34, s64, v48
    v_lshlrev_b32 v33, 16, v74
    v_and_b32 v35, s64, v74
    v_lshlrev_b32 v40, 16, v76
    v_and_b32 v42, s64, v76
    v_lshlrev_b32 v41, 16, v78
    v_and_b32 v43, s64, v78
    v_lshlrev_b32 v36, 16, v49
    v_and_b32 v38, s64, v49
    v_lshlrev_b32 v37, 16, v75
    v_and_b32 v39, s64, v75
    v_lshlrev_b32 v44, 16, v77
    v_and_b32 v46, s64, v77
    v_lshlrev_b32 v45, 16, v79
    v_and_b32 v47, s64, v79
    v_pk_mul_f32 v[32:33], v[32:33], v[4:5]
    v_pk_mul_f32 v[40:41], v[40:41], v[98:99] op_sel_hi:[1,0]
    v_pk_mul_f32 v[34:35], v[34:35], v[4:5]
    v_pk_mul_f32 v[42:43], v[42:43], v[98:99] op_sel_hi:[1,0]
    v_pk_mul_f32 v[36:37], v[36:37], v[4:5]
    v_pk_mul_f32 v[44:45], v[44:45], v[98:99] op_sel_hi:[1,0]
    v_pk_mul_f32 v[38:39], v[38:39], v[4:5]
    v_pk_mul_f32 v[46:47], v[46:47], v[98:99] op_sel_hi:[1,0]
    v_pk_mul_f32 v[48:49], v[32:33], v[8:9] op_sel_hi:[1,0]
    v_pk_mul_f32 v[50:51], v[34:35], v[8:9] op_sel_hi:[1,0]
    v_pk_mul_f32 v[52:53], v[36:37], v[8:9] op_sel_hi:[1,0]
    v_pk_mul_f32 v[54:55], v[38:39], v[8:9] op_sel_hi:[1,0]
    v_fract_f32 v49, v49
    v_fract_f32 v51, v51
    v_fract_f32 v53, v53
    v_fract_f32 v55, v55
    v_exp_f32 v48, v48
    v_cos_f32 v56, v49
    v_sin_f32 v57, v49
    v_exp_f32 v50, v50
    v_cos_f32 v58, v51
    v_sin_f32 v59, v51
    v_exp_f32 v52, v52
    v_cos_f32 v60, v53
    v_sin_f32 v61, v53
    v_exp_f32 v54, v54
    v_cos_f32 v62, v55
    v_sin_f32 v63, v55
    v_pk_mul_f32 v[56:57], v[56:57], v[48:49] op_sel_hi:[1,0]
    v_pk_mul_f32 v[58:59], v[58:59], v[50:51] op_sel_hi:[1,0]
    v_pk_mul_f32 v[60:61], v[60:61], v[52:53] op_sel_hi:[1,0]
    v_pk_mul_f32 v[62:63], v[62:63], v[54:55] op_sel_hi:[1,0]
    v_pk_mul_f32 v[100:101], v[56:57], v[40:41] op_sel_hi:[1,0] neg_hi:[0,1]
    v_pk_mul_f32 v[102:103], v[58:59], v[42:43] op_sel_hi:[1,0] neg_hi:[0,1]
    v_pk_mul_f32 v[104:105], v[60:61], v[44:45] op_sel_hi:[1,0] neg_hi:[0,1]
    v_pk_mul_f32 v[106:107], v[62:63], v[46:47] op_sel_hi:[1,0] neg_hi:[0,1]
    v_fma_f32 v100, -v41, v57, v100
    v_fma_f32 v101, -v41, v56, v101
    v_fma_f32 v102, -v43, v59, v102
    v_fma_f32 v103, -v43, v58, v103
    v_fma_f32 v104, -v45, v61, v104
    v_fma_f32 v105, -v45, v60, v105
    v_fma_f32 v106, -v47, v63, v106
    v_fma_f32 v107, -v47, v62, v107
    v_cvt_pk_f16_f32 v108, v100, v101
    v_cvt_pk_f16_f32 v109, v102, v103
    v_cvt_pk_f16_f32 v110, v104, v105
    v_cvt_pk_f16_f32 v111, v106, v107
    v_pk_mul_f32 v[48:49], v[32:33], v[10:11] op_sel_hi:[1,0]
    v_pk_mul_f32 v[50:51], v[34:35], v[10:11] op_sel_hi:[1,0]
    v_pk_mul_f32 v[52:53], v[36:37], v[10:11] op_sel_hi:[1,0]
    v_pk_mul_f32 v[54:55], v[38:39], v[10:11] op_sel_hi:[1,0]
    v_fract_f32 v49, v49
    v_fract_f32 v51, v51
    v_fract_f32 v53, v53
    v_fract_f32 v55, v55
    v_exp_f32 v48, v48
    v_cos_f32 v56, v49
    v_sin_f32 v57, v49
    v_exp_f32 v50, v50
    v_cos_f32 v58, v51
    v_sin_f32 v59, v51
    v_exp_f32 v52, v52
    v_cos_f32 v60, v53
    v_sin_f32 v61, v53
    v_exp_f32 v54, v54
    v_cos_f32 v62, v55
    v_sin_f32 v63, v55
    v_pk_mul_f32 v[56:57], v[56:57], v[48:49] op_sel_hi:[1,0]
    v_pk_mul_f32 v[58:59], v[58:59], v[50:51] op_sel_hi:[1,0]
    v_pk_mul_f32 v[60:61], v[60:61], v[52:53] op_sel_hi:[1,0]
    v_pk_mul_f32 v[62:63], v[62:63], v[54:55] op_sel_hi:[1,0]
    v_cvt_pk_f16_f32 v112, v56, v57
    v_cvt_pk_f16_f32 v113, v58, v59
    v_cvt_pk_f16_f32 v114, v60, v61
    v_cvt_pk_f16_f32 v115, v62, v63
    s_nop 5
    v_mfma_f32_16x16x32_f16 v[116:119], v[108:111], v[112:115], v[116:119]
    v_pk_mul_f32 v[48:49], v[32:33], v[28:29] op_sel_hi:[1,0]
    v_pk_mul_f32 v[50:51], v[34:35], v[28:29] op_sel_hi:[1,0]
    v_pk_mul_f32 v[52:53], v[36:37], v[28:29] op_sel_hi:[1,0]
    v_pk_mul_f32 v[54:55], v[38:39], v[28:29] op_sel_hi:[1,0]
    v_fract_f32 v49, v49
    v_fract_f32 v51, v51
    v_fract_f32 v53, v53
    v_fract_f32 v55, v55
    v_exp_f32 v48, v48
    v_cos_f32 v56, v49
    v_sin_f32 v57, v49
    v_exp_f32 v50, v50
    v_cos_f32 v58, v51
    v_sin_f32 v59, v51
    v_exp_f32 v52, v52
    v_cos_f32 v60, v53
    v_sin_f32 v61, v53
    v_exp_f32 v54, v54
    v_cos_f32 v62, v55
    v_sin_f32 v63, v55
    v_pk_mul_f32 v[56:57], v[56:57], v[48:49] op_sel_hi:[1,0]
    v_pk_mul_f32 v[58:59], v[58:59], v[50:51] op_sel_hi:[1,0]
    v_pk_mul_f32 v[60:61], v[60:61], v[52:53] op_sel_hi:[1,0]
    v_pk_mul_f32 v[62:63], v[62:63], v[54:55] op_sel_hi:[1,0]
    v_cvt_pk_f16_f32 v112, v56, v57
    v_cvt_pk_f16_f32 v113, v58, v59
    v_cvt_pk_f16_f32 v114, v60, v61
    v_cvt_pk_f16_f32 v115, v62, v63
    s_nop 5
    v_mfma_f32_16x16x32_f16 v[120:123], v[108:111], v[112:115], v[120:123]
    v_pk_mul_f32 v[48:49], v[32:33], v[30:31] op_sel_hi:[1,0]
    v_pk_mul_f32 v[50:51], v[34:35], v[30:31] op_sel_hi:[1,0]
    v_pk_mul_f32 v[52:53], v[36:37], v[30:31] op_sel_hi:[1,0]
    v_pk_mul_f32 v[54:55], v[38:39], v[30:31] op_sel_hi:[1,0]
    v_fract_f32 v49, v49
    v_fract_f32 v51, v51
    v_fract_f32 v53, v53
    v_fract_f32 v55, v55
    v_exp_f32 v48, v48
    v_cos_f32 v56, v49
    v_sin_f32 v57, v49
    v_exp_f32 v50, v50
    v_cos_f32 v58, v51
    v_sin_f32 v59, v51
    v_exp_f32 v52, v52
    v_cos_f32 v60, v53
    v_sin_f32 v61, v53
    v_exp_f32 v54, v54
    v_cos_f32 v62, v55
    v_sin_f32 v63, v55
    v_pk_mul_f32 v[56:57], v[56:57], v[48:49] op_sel_hi:[1,0]
    v_pk_mul_f32 v[58:59], v[58:59], v[50:51] op_sel_hi:[1,0]
    v_pk_mul_f32 v[60:61], v[60:61], v[52:53] op_sel_hi:[1,0]
    v_pk_mul_f32 v[62:63], v[62:63], v[54:55] op_sel_hi:[1,0]
    v_cvt_pk_f16_f32 v112, v56, v57
    v_cvt_pk_f16_f32 v113, v58, v59
    v_cvt_pk_f16_f32 v114, v60, v61
    v_cvt_pk_f16_f32 v115, v62, v63
    s_nop 5
    v_mfma_f32_16x16x32_f16 v[124:127], v[108:111], v[112:115], v[124:127]
    v_lshl_add_u32 v4, v0, 2, s45
    s_mul_i32 s8, s3, 4160
    s_add_u32 s12, s8, 0x1000000
    s_add_u32 s8, s8, 0x400000
    v_lshlrev_b32 v5, 4, v0
    s_lshl_b32 s9, s3, 2
    s_add_u32 s9, s9, 0x680000
    ds_write_b32 v12, v116
    v_add_u32 v12, v12, v15
    ds_write_b32 v12, v117
    v_add_u32 v12, v12, v15
    ds_write_b32 v12, v118
    v_add_u32 v12, v12, v15
    ds_write_b32 v12, v119
    ds_write_b32 v13, v120
    v_add_u32 v13, v13, v16
    ds_write_b32 v13, v121
    v_add_u32 v13, v13, v16
    ds_write_b32 v13, v122
    v_add_u32 v13, v13, v16
    ds_write_b32 v13, v123
    s_nop 10
    ds_write_b32 v14, v124
    v_add_u32 v14, v14, v17
    ds_write_b32 v14, v125
    v_add_u32 v14, v14, v17
    ds_write_b32 v14, v126
    v_add_u32 v14, v14, v17
    ds_write_b32 v14, v127
    s_waitcnt lgkmcnt(0)
    s_barrier
    ds_read_b32 v32, v4 offset:0
    ds_read_b32 v33, v4 offset:2816
    ds_read_b32 v34, v4 offset:5632
    ds_read_b32 v35, v4 offset:8448
    ds_read_b32 v36, v4 offset:1024
    ds_read_b32 v37, v4 offset:3840
    ds_read_b32 v38, v4 offset:6656
    ds_read_b32 v39, v4 offset:9472
    ds_read_b32 v40, v4 offset:2048
    ds_read_b32 v41, v4 offset:4864
    ds_read_b32 v42, v4 offset:7680
    ds_read_b32 v43, v4 offset:10496
    s_waitcnt lgkmcnt(0)
    v_pk_add_f32 v[32:33], v[32:33], v[34:35]
    v_pk_add_f32 v[36:37], v[36:37], v[38:39]
    v_pk_add_f32 v[40:41], v[40:41], v[42:43]
    v_add_f32 v32, v32, v33
    v_add_f32 v36, v36, v37
    v_add_f32 v40, v40, v41
    ds_write_b32 v4, v32 offset:11264
    ds_write_b32 v4, v36 offset:12288
    ds_write_b32 v4, v40 offset:13312
    s_waitcnt lgkmcnt(0)
    s_barrier
    ds_read_b32 v32, v18 offset:11264
    ds_read_b32 v33, v19 offset:11264
    ds_read_b32 v34, v20 offset:11264
    ds_read_b32 v35, v21 offset:11264
    ds_read_b32 v36, v22 offset:11264
    ds_read_b32 v37, v23 offset:11264
    ds_read_b32 v38, v24 offset:11264
    ds_read_b32 v39, v25 offset:11264
    ds_read_b32 v40, v26 offset:11264
    v_cmp_gt_u32 vcc, 255, v0
    v_mov_b64 v[52:53], 0
    v_mov_b64 v[54:55], 0
    s_waitcnt lgkmcnt(0)
    v_cndmask_b32 v40, 0, v40, vcc
    v_cvt_pk_f16_f32 v44, v32, v33
    v_cvt_pk_f16_f32 v48, v33, v34
    v_cvt_pk_f16_f32 v45, v34, v35
    v_cvt_pk_f16_f32 v49, v35, v36
    v_cvt_pk_f16_f32 v46, v36, v37
    v_cvt_pk_f16_f32 v50, v37, v38
    v_cvt_pk_f16_f32 v47, v38, v39
    v_cvt_pk_f16_f32 v51, v39, v40
    buffer_store_dwordx4 v[44:47], v5, s[24:27], s8 offen sc1
    buffer_store_dwordx4 v[48:51], v5, s[24:27], s12 offen sc1
    v_add_u32 v5, 4096, v5
    v_cmp_gt_u32 vcc, 4, v0
    s_nop 0
    s_and_saveexec_b64 s[10:11], vcc
    s_cbranch_execz P_done2
    buffer_store_dwordx4 v[52:55], v5, s[24:27], s8 offen sc1
    buffer_store_dwordx4 v[52:55], v5, s[24:27], s12 offen sc1
P_done2:
    s_mov_b64 exec, -1
    v_mov_b32 v22, v99
    s_waitcnt vmcnt(0)
    s_barrier
    s_mul_i32 s45, s47, 40192
    v_sub_u32 v3, 2079, v1
    v_and_b32 v4, 1, v3
    v_and_b32 v3, 0xfffffffe, v3
    v_lshlrev_b32 v3, 1, v3
    s_mov_b32 s40, 0xc00000
    v_mul_lo_u32 v4, v4, s40
    v_add_u32 v3, v3, v4
    s_mul_i32 s40, s3, 4160
    s_add_u32 s40, s40, 0x400000
    s_lshl_b32 s41, s46, 7
    s_sub_u32 s40, s40, s41
    s_lshl_b32 s41, s46, 10
    s_add_u32 s41, s41, s45
    s_lshl_b32 s43, s3, 12
    s_mov_b32 s36, s14
    s_mov_b32 s37, s15
    s_mov_b32 s38, 0x400
    s_mov_b32 s39, 0x00020000
    v_mov_b32 v5, 0
    s_lshl_b32 s44, s3, 1
    buffer_load_ushort v20, v5, s[36:39], s44 offen
    s_sub_u32 s42, s40, 0
    s_add_u32 m0, s41, 0
    s_nop 0
    buffer_load_dwordx4 v3, s[24:27], s42 offen sc1 lds
    s_sub_u32 s42, s40, 512
    s_add_u32 m0, s41, 4096
    s_nop 0
    buffer_load_dwordx4 v3, s[24:27], s42 offen sc1 lds
    s_sub_u32 s42, s40, 1024
    s_add_u32 m0, s41, 8192
    s_nop 0
    buffer_load_dwordx4 v3, s[24:27], s42 offen sc1 lds
    s_sub_u32 s42, s40, 1536
    s_add_u32 m0, s41, 12288
    s_nop 0
    buffer_load_dwordx4 v3, s[24:27], s42 offen sc1 lds
    s_sub_u32 s42, s40, 2048
    s_add_u32 m0, s41, 16384
    s_nop 0
    buffer_load_dwordx4 v3, s[24:27], s42 offen sc1 lds
    s_sub_u32 s42, s40, 2560
    s_add_u32 m0, s41, 20480
    s_nop 0
    buffer_load_dwordx4 v3, s[24:27], s42 offen sc1 lds
    s_sub_u32 s42, s40, 3072
    s_add_u32 m0, s41, 24576
    s_nop 0
    buffer_load_dwordx4 v3, s[24:27], s42 offen sc1 lds
    s_sub_u32 s42, s40, 3584
    s_add_u32 m0, s41, 28672
    s_nop 0
    buffer_load_dwordx4 v3, s[24:27], s42 offen sc1 lds
    s_cmp_lg_u32 s46, 0
    s_cbranch_scc1 C_skip33
    s_sub_u32 s42, s40, 4096
    s_add_u32 m0, s41, 32768
    s_nop 0
    buffer_load_dwordx4 v3, s[24:27], s42 offen sc1 lds
C_skip33:
    s_or_b32 s40, s46, s47
    s_cmp_lg_u32 s40, 0
    s_cbranch_scc1 C_go
    v_mov_b32 v4, 0
    s_mov_b32 s86, 0
C_wi:
    buffer_load_dword v5, v4, s[68:71], 0 offen sc1
    s_waitcnt vmcnt(0)
    v_readfirstlane_b32 s52, v5
    s_nop 0
    s_cmp_lg_u32 s52, 0
    s_cbranch_scc1 C_wi_ok
    s_sleep 16
    s_add_u32 s86, s86, 1
    s_cmp_lt_u32 s86, 0x40000
    s_cbranch_scc1 C_wi
C_wi_ok:
    v_and_b32 v4, 15, v1
    v_lshlrev_b32 v4, 8, v4
    s_mov_b32 s40, 0x6a1100
    s_mov_b32 s86, 0
C_poll:
    buffer_load_dword v5, v4, s[24:27], s40 offen sc1
    s_waitcnt vmcnt(0)
    v_cmp_gt_u32 vcc, 16, v5
    s_nop 4
    s_cmp_eq_u64 vcc, 0
    s_cbranch_scc1 C_go
    s_sleep 12
    s_add_u32 s86, s86, 1
    s_cmp_lt_u32 s86, 0x40000
    s_cbranch_scc1 C_poll
C_go:
    s_barrier
    v_lshlrev_b32 v4, 13, v0
    s_lshl_b32 s44, s3, 4
    s_add_u32 s44, s44, 0x200000
    buffer_load_dwordx4 v[8:11], v4, s[24:27], s44 offen sc1
    v_lshlrev_b32 v4, 4, v0
    v_mov_b64 v[12:13], 0
    v_mov_b64 v[14:15], 0
    v_min_u32 v5, 1264, v4
    v_add_u32 v5, s45, v5
    ds_write_b128 v5, v[12:15] offset:33792
    v_lshrrev_b32 v5, 2, v0
    v_mul_u32_u24 v5, 80, v5
    v_and_b32 v6, 3, v0
    v_lshl_add_u32 v5, v6, 4, v5
    v_add_u32 v5, s45, v5
    v_and_b32 v6, 15, v1
    v_lshrrev_b32 v7, 4, v1
    v_lshlrev_b32 v16, 4, v6
    v_lshlrev_b32 v17, 7, v7
    v_sub_u32 v16, v16, v17
    v_lshl_add_u32 v16, v2, 9, v16
    v_add_u32 v16, s45, v16
    v_add_u32 v16, 512, v16
    v_add_u32 v17, 4, v6
    v_sub_u32 v17, v17, v2
    v_mul_u32_u24 v17, 80, v17
    v_lshl_add_u32 v17, v7, 4, v17
    v_add_u32 v17, s45, v17
    v_mov_b64 v[96:97], 0
    v_mov_b64 v[98:99], 0
    v_mov_b64 v[100:101], 0
    v_mov_b64 v[102:103], 0
    v_mov_b64 v[104:105], 0
    v_mov_b64 v[106:107], 0
    v_mov_b64 v[108:109], 0
    v_mov_b64 v[110:111], 0
    v_mov_b64 v[112:113], 0
    v_mov_b64 v[114:115], 0
    v_mov_b64 v[116:117], 0
    v_mov_b64 v[118:119], 0
    v_mov_b64 v[120:121], 0
    v_mov_b64 v[122:123], 0
    v_mov_b64 v[124:125], 0
    v_mov_b64 v[126:127], 0
    s_waitcnt vmcnt(0)
    ds_write_b128 v5, v[8:11] offset:35072
    s_waitcnt vmcnt(0) lgkmcnt(0)
    s_barrier
    ds_read_b128 v[56:59], v17 offset:34752
    ds_read_b128 v[60:63], v17 offset:36032
    ds_read_b128 v[64:67], v17 offset:37312
    ds_read_b128 v[68:71], v17 offset:38592
    ds_read_b128 v[24:27], v16 offset:0
    ds_read_b128 v[28:31], v16 offset:256
    ds_read_b128 v[32:35], v16 offset:8192
    ds_read_b128 v[36:39], v16 offset:8448
    ds_read_b128 v[40:43], v16 offset:16384
    ds_read_b128 v[44:47], v16 offset:16640
    ds_read_b128 v[48:51], v16 offset:24576
    ds_read_b128 v[52:55], v16 offset:24832
    s_waitcnt lgkmcnt(8)
    ds_read_b128 v[72:75], v17 offset:34432
    ds_read_b128 v[76:79], v17 offset:35712
    ds_read_b128 v[80:83], v17 offset:36992
    ds_read_b128 v[84:87], v17 offset:38272
    s_waitcnt lgkmcnt(10)
    v_mfma_f32_16x16x32_f16 v[96:99], v[24:27], v[56:59], v[96:99]
    v_mfma_f32_16x16x32_f16 v[112:115], v[28:31], v[56:59], v[112:115]
    v_mfma_f32_16x16x32_f16 v[100:103], v[24:27], v[60:63], v[100:103]
    v_mfma_f32_16x16x32_f16 v[116:119], v[28:31], v[60:63], v[116:119]
    v_mfma_f32_16x16x32_f16 v[104:107], v[24:27], v[64:67], v[104:107]
    v_mfma_f32_16x16x32_f16 v[120:123], v[28:31], v[64:67], v[120:123]
    v_mfma_f32_16x16x32_f16 v[108:111], v[24:27], v[68:71], v[108:111]
    v_mfma_f32_16x16x32_f16 v[124:127], v[28:31], v[68:71], v[124:127]
    ds_read_b128 v[24:27], v16 offset:2048
    ds_read_b128 v[28:31], v16 offset:2304
    s_waitcnt lgkmcnt(10)
    v_mfma_f32_16x16x32_f16 v[100:103], v[32:35], v[56:59], v[100:103]
    v_mfma_f32_16x16x32_f16 v[116:119], v[36:39], v[56:59], v[116:119]
    v_mfma_f32_16x16x32_f16 v[104:107], v[32:35], v[60:63], v[104:107]
    v_mfma_f32_16x16x32_f16 v[120:123], v[36:39], v[60:63], v[120:123]
    v_mfma_f32_16x16x32_f16 v[108:111], v[32:35], v[64:67], v[108:111]
    v_mfma_f32_16x16x32_f16 v[124:127], v[36:39], v[64:67], v[124:127]
    ds_read_b128 v[32:35], v16 offset:10240
    ds_read_b128 v[36:39], v16 offset:10496
    s_waitcnt lgkmcnt(10)
    v_mfma_f32_16x16x32_f16 v[104:107], v[40:43], v[56:59], v[104:107]
    v_mfma_f32_16x16x32_f16 v[120:123], v[44:47], v[56:59], v[120:123]
    v_mfma_f32_16x16x32_f16 v[108:111], v[40:43], v[60:63], v[108:111]
    v_mfma_f32_16x16x32_f16 v[124:127], v[44:47], v[60:63], v[124:127]
    ds_read_b128 v[40:43], v16 offset:18432
    ds_read_b128 v[44:47], v16 offset:18688
    s_waitcnt lgkmcnt(10)
    v_mfma_f32_16x16x32_f16 v[108:111], v[48:51], v[56:59], v[108:111]
    v_mfma_f32_16x16x32_f16 v[124:127], v[52:55], v[56:59], v[124:127]
    ds_read_b128 v[48:51], v16 offset:26624
    ds_read_b128 v[52:55], v16 offset:26880
    ds_read_b128 v[56:59], v17 offset:34112
    ds_read_b128 v[60:63], v17 offset:35392
    ds_read_b128 v[64:67], v17 offset:36672
    ds_read_b128 v[68:71], v17 offset:37952
    s_waitcnt lgkmcnt(10)
    v_mfma_f32_16x16x32_f16 v[96:99], v[24:27], v[72:75], v[96:99]
    v_mfma_f32_16x16x32_f16 v[112:115], v[28:31], v[72:75], v[112:115]
    v_mfma_f32_16x16x32_f16 v[100:103], v[24:27], v[76:79], v[100:103]
    v_mfma_f32_16x16x32_f16 v[116:119], v[28:31], v[76:79], v[116:119]
    v_mfma_f32_16x16x32_f16 v[104:107], v[24:27], v[80:83], v[104:107]
    v_mfma_f32_16x16x32_f16 v[120:123], v[28:31], v[80:83], v[120:123]
    v_mfma_f32_16x16x32_f16 v[108:111], v[24:27], v[84:87], v[108:111]
    v_mfma_f32_16x16x32_f16 v[124:127], v[28:31], v[84:87], v[124:127]
    ds_read_b128 v[24:27], v16 offset:4096
    ds_read_b128 v[28:31], v16 offset:4352
    s_waitcnt lgkmcnt(10)
    v_mfma_f32_16x16x32_f16 v[100:103], v[32:35], v[72:75], v[100:103]
    v_mfma_f32_16x16x32_f16 v[116:119], v[36:39], v[72:75], v[116:119]
    v_mfma_f32_16x16x32_f16 v[104:107], v[32:35], v[76:79], v[104:107]
    v_mfma_f32_16x16x32_f16 v[120:123], v[36:39], v[76:79], v[120:123]
    v_mfma_f32_16x16x32_f16 v[108:111], v[32:35], v[80:83], v[108:111]
    v_mfma_f32_16x16x32_f16 v[124:127], v[36:39], v[80:83], v[124:127]
    ds_read_b128 v[32:35], v16 offset:12288
    ds_read_b128 v[36:39], v16 offset:12544
    s_waitcnt lgkmcnt(10)
    v_mfma_f32_16x16x32_f16 v[104:107], v[40:43], v[72:75], v[104:107]
    v_mfma_f32_16x16x32_f16 v[120:123], v[44:47], v[72:75], v[120:123]
    v_mfma_f32_16x16x32_f16 v[108:111], v[40:43], v[76:79], v[108:111]
    v_mfma_f32_16x16x32_f16 v[124:127], v[44:47], v[76:79], v[124:127]
    ds_read_b128 v[40:43], v16 offset:20480
    ds_read_b128 v[44:47], v16 offset:20736
    s_waitcnt lgkmcnt(10)
    v_mfma_f32_16x16x32_f16 v[108:111], v[48:51], v[72:75], v[108:111]
    v_mfma_f32_16x16x32_f16 v[124:127], v[52:55], v[72:75], v[124:127]
    ds_read_b128 v[48:51], v16 offset:28672
    ds_read_b128 v[52:55], v16 offset:28928
    ds_read_b128 v[72:75], v17 offset:33792
    ds_read_b128 v[76:79], v17 offset:35072
    ds_read_b128 v[80:83], v17 offset:36352
    ds_read_b128 v[84:87], v17 offset:37632
    s_waitcnt lgkmcnt(10)
    v_mfma_f32_16x16x32_f16 v[96:99], v[24:27], v[56:59], v[96:99]
    v_mfma_f32_16x16x32_f16 v[112:115], v[28:31], v[56:59], v[112:115]
    v_mfma_f32_16x16x32_f16 v[100:103], v[24:27], v[60:63], v[100:103]
    v_mfma_f32_16x16x32_f16 v[116:119], v[28:31], v[60:63], v[116:119]
    v_mfma_f32_16x16x32_f16 v[104:107], v[24:27], v[64:67], v[104:107]
    v_mfma_f32_16x16x32_f16 v[120:123], v[28:31], v[64:67], v[120:123]
    v_mfma_f32_16x16x32_f16 v[108:111], v[24:27], v[68:71], v[108:111]
    v_mfma_f32_16x16x32_f16 v[124:127], v[28:31], v[68:71], v[124:127]
    ds_read_b128 v[24:27], v16 offset:6144
    ds_read_b128 v[28:31], v16 offset:6400
    s_waitcnt lgkmcnt(10)
    v_mfma_f32_16x16x32_f16 v[100:103], v[32:35], v[56:59], v[100:103]
    v_mfma_f32_16x16x32_f16 v[116:119], v[36:39], v[56:59], v[116:119]
    v_mfma_f32_16x16x32_f16 v[104:107], v[32:35], v[60:63], v[104:107]
    v_mfma_f32_16x16x32_f16 v[120:123], v[36:39], v[60:63], v[120:123]
    v_mfma_f32_16x16x32_f16 v[108:111], v[32:35], v[64:67], v[108:111]
    v_mfma_f32_16x16x32_f16 v[124:127], v[36:39], v[64:67], v[124:127]
    ds_read_b128 v[32:35], v16 offset:14336
    ds_read_b128 v[36:39], v16 offset:14592
    s_waitcnt lgkmcnt(10)
    v_mfma_f32_16x16x32_f16 v[104:107], v[40:43], v[56:59], v[104:107]
    v_mfma_f32_16x16x32_f16 v[120:123], v[44:47], v[56:59], v[120:123]
    v_mfma_f32_16x16x32_f16 v[108:111], v[40:43], v[60:63], v[108:111]
    v_mfma_f32_16x16x32_f16 v[124:127], v[44:47], v[60:63], v[124:127]
    ds_read_b128 v[40:43], v16 offset:22528
    ds_read_b128 v[44:47], v16 offset:22784
    s_waitcnt lgkmcnt(10)
    v_mfma_f32_16x16x32_f16 v[108:111], v[48:51], v[56:59], v[108:111]
    v_mfma_f32_16x16x32_f16 v[124:127], v[52:55], v[56:59], v[124:127]
    ds_read_b128 v[48:51], v16 offset:30720
    ds_read_b128 v[52:55], v16 offset:30976
    s_waitcnt lgkmcnt(6)
    v_mfma_f32_16x16x32_f16 v[96:99], v[24:27], v[72:75], v[96:99]
    v_mfma_f32_16x16x32_f16 v[112:115], v[28:31], v[72:75], v[112:115]
    v_mfma_f32_16x16x32_f16 v[100:103], v[24:27], v[76:79], v[100:103]
    v_mfma_f32_16x16x32_f16 v[116:119], v[28:31], v[76:79], v[116:119]
    v_mfma_f32_16x16x32_f16 v[104:107], v[24:27], v[80:83], v[104:107]
    v_mfma_f32_16x16x32_f16 v[120:123], v[28:31], v[80:83], v[120:123]
    v_mfma_f32_16x16x32_f16 v[108:111], v[24:27], v[84:87], v[108:111]
    v_mfma_f32_16x16x32_f16 v[124:127], v[28:31], v[84:87], v[124:127]
    s_waitcnt lgkmcnt(4)
    v_mfma_f32_16x16x32_f16 v[100:103], v[32:35], v[72:75], v[100:103]
    v_mfma_f32_16x16x32_f16 v[116:119], v[36:39], v[72:75], v[116:119]
    v_mfma_f32_16x16x32_f16 v[104:107], v[32:35], v[76:79], v[104:107]
    v_mfma_f32_16x16x32_f16 v[120:123], v[36:39], v[76:79], v[120:123]
    v_mfma_f32_16x16x32_f16 v[108:111], v[32:35], v[80:83], v[108:111]
    v_mfma_f32_16x16x32_f16 v[124:127], v[36:39], v[80:83], v[124:127]
    s_waitcnt lgkmcnt(2)
    v_mfma_f32_16x16x32_f16 v[104:107], v[40:43], v[72:75], v[104:107]
    v_mfma_f32_16x16x32_f16 v[120:123], v[44:47], v[72:75], v[120:123]
    v_mfma_f32_16x16x32_f16 v[108:111], v[40:43], v[76:79], v[108:111]
    v_mfma_f32_16x16x32_f16 v[124:127], v[44:47], v[76:79], v[124:127]
    s_waitcnt lgkmcnt(0)
    v_mfma_f32_16x16x32_f16 v[108:111], v[48:51], v[72:75], v[108:111]
    v_mfma_f32_16x16x32_f16 v[124:127], v[52:55], v[72:75], v[124:127]
    v_lshlrev_b32 v4, 4, v1
    v_add_u32 v4, s45, v4
    v_lshl_add_u32 v5, v2, 11, v4
    v_lshl_add_u32 v4, v2, 13, v4
    v_and_b32 v8, 1, v2
    v_lshl_add_u32 v8, v8, 5, v6
    v_lshrrev_b32 v9, 1, v2
    v_lshlrev_b32 v9, 5, v9
    v_lshl_add_u32 v9, v7, 3, v9
    v_mul_u32_u24 v10, 80, v8
    v_add_u32 v10, v10, v9
    v_add_u32 v10, s45, v10
    v_lshl_add_u32 v11, v8, 6, v9
    v_add_u32 v11, s45, v11
    s_add_u32 s43, s43, 0x700000
    v_lshlrev_b32 v20, 16, v20
    v_mul_f32 v20, 0x3a800000, v20
    s_barrier
    ds_write_b128 v4, v[96:99] offset:0
    ds_write_b128 v4, v[100:103] offset:1024
    s_nop 5
    ds_write_b128 v4, v[104:107] offset:2048
    s_nop 3
    ds_write_b128 v4, v[108:111] offset:3072
    ds_write_b128 v4, v[112:115] offset:4096
    ds_write_b128 v4, v[116:119] offset:5120
    ds_write_b128 v4, v[120:123] offset:6144
    ds_write_b128 v4, v[124:127] offset:7168
    ds_read_b64 v[12:13], v10 offset:35072
    ds_read_b64 v[14:15], v10 offset:36352
    s_waitcnt lgkmcnt(0)
    s_barrier
    ds_read_b128 v[24:27], v5 offset:0
    ds_read_b128 v[28:31], v5 offset:8192
    ds_read_b128 v[32:35], v5 offset:16384
    ds_read_b128 v[36:39], v5 offset:24576
    ds_read_b128 v[40:43], v5 offset:1024
    ds_read_b128 v[44:47], v5 offset:9216
    ds_read_b128 v[48:51], v5 offset:17408
    ds_read_b128 v[52:55], v5 offset:25600
    v_cvt_f32_f16 v68, v12
    v_lshrrev_b32 v69, 16, v12
    v_cvt_f32_f16 v70, v13
    v_lshrrev_b32 v71, 16, v13
    v_cvt_f32_f16 v69, v69
    v_cvt_f32_f16 v71, v71
    v_pk_mul_f32 v[68:69], v[68:69], v[20:21] op_sel_hi:[1,0]
    v_pk_mul_f32 v[70:71], v[70:71], v[20:21] op_sel_hi:[1,0]
    v_cvt_pk_bf16_f32 v74, v68, v69
    v_cvt_pk_bf16_f32 v75, v70, v71
    v_lshlrev_b32 v68, 16, v74
    v_and_b32 v69, s64, v74
    v_lshlrev_b32 v70, 16, v75
    v_and_b32 v71, s64, v75
    v_cvt_f32_f16 v84, v14
    v_lshrrev_b32 v85, 16, v14
    v_cvt_f32_f16 v86, v15
    v_lshrrev_b32 v87, 16, v15
    v_cvt_f32_f16 v85, v85
    v_cvt_f32_f16 v87, v87
    v_pk_mul_f32 v[84:85], v[84:85], v[20:21] op_sel_hi:[1,0]
    v_pk_mul_f32 v[86:87], v[86:87], v[20:21] op_sel_hi:[1,0]
    v_cvt_pk_bf16_f32 v90, v84, v85
    v_cvt_pk_bf16_f32 v91, v86, v87
    v_lshlrev_b32 v84, 16, v90
    v_and_b32 v85, s64, v90
    v_lshlrev_b32 v86, 16, v91
    v_and_b32 v87, s64, v91
    s_waitcnt lgkmcnt(0)
    v_pk_add_f32 v[24:25], v[24:25], v[28:29]
    v_pk_add_f32 v[32:33], v[32:33], v[36:37]
    v_pk_add_f32 v[26:27], v[26:27], v[30:31]
    v_pk_add_f32 v[34:35], v[34:35], v[38:39]
    v_pk_add_f32 v[64:65], v[24:25], v[32:33]
    v_pk_add_f32 v[66:67], v[26:27], v[34:35]
    v_pk_mul_f32 v[64:65], v[64:65], v[22:23] op_sel_hi:[1,0]
    v_pk_mul_f32 v[66:67], v[66:67], v[22:23] op_sel_hi:[1,0]
    v_cvt_pk_bf16_f32 v72, v64, v65
    v_cvt_pk_bf16_f32 v73, v66, v67
    v_lshlrev_b32 v64, 16, v72
    v_and_b32 v65, s64, v72
    v_lshlrev_b32 v66, 16, v73
    v_and_b32 v67, s64, v73
    v_pk_add_f32 v[64:65], v[64:65], v[68:69]
    v_pk_add_f32 v[66:67], v[66:67], v[70:71]
    v_cvt_pk_bf16_f32 v72, v64, v65
    v_cvt_pk_bf16_f32 v73, v66, v67
    v_pk_add_f32 v[40:41], v[40:41], v[44:45]
    v_pk_add_f32 v[48:49], v[48:49], v[52:53]
    v_pk_add_f32 v[42:43], v[42:43], v[46:47]
    v_pk_add_f32 v[50:51], v[50:51], v[54:55]
    v_pk_add_f32 v[80:81], v[40:41], v[48:49]
    v_pk_add_f32 v[82:83], v[42:43], v[50:51]
    v_pk_mul_f32 v[80:81], v[80:81], v[22:23] op_sel_hi:[1,0]
    v_pk_mul_f32 v[82:83], v[82:83], v[22:23] op_sel_hi:[1,0]
    v_cvt_pk_bf16_f32 v88, v80, v81
    v_cvt_pk_bf16_f32 v89, v82, v83
    v_lshlrev_b32 v80, 16, v88
    v_and_b32 v81, s64, v88
    v_lshlrev_b32 v82, 16, v89
    v_and_b32 v83, s64, v89
    v_pk_add_f32 v[80:81], v[80:81], v[84:85]
    v_pk_add_f32 v[82:83], v[82:83], v[86:87]
    v_cvt_pk_bf16_f32 v88, v80, v81
    v_cvt_pk_bf16_f32 v89, v82, v83
    v_lshlrev_b32 v4, 4, v0
    v_add_u32 v5, s45, v4
    s_barrier
    ds_write_b64 v11, v[72:73] offset:0
    ds_write_b64 v11, v[88:89] offset:1024
    s_waitcnt lgkmcnt(0)
    s_barrier
    ds_read_b128 v[24:27], v5
    s_waitcnt lgkmcnt(0)
    buffer_store_dwordx4 v[24:27], v4, s[24:27], s43 offen sc1
    s_waitcnt vmcnt(0)
    s_barrier
C_sig:
    s_or_b32 s40, s46, s47
    s_cmp_lg_u32 s40, 0
    s_cbranch_scc1 C_end
    v_mov_b32 v24, 1
    v_mov_b32 v25, 0
    s_lshr_b32 s40, s3, 6
    s_lshl_b32 s40, s40, 8
    s_add_u32 s40, s40, 0x6a2800
    s_mov_b64 exec, 1
    buffer_atomic_add v24, v25, s[24:27], s40 offen sc1
    s_mov_b64 exec, -1
C_end:
    s_endpgm
F_done:
    s_endpgm
.section .rodata,"a"
.p2align 6
.amdhsa_kernel fin_kernel
  .amdhsa_next_free_vgpr 128
  .amdhsa_next_free_sgpr 102
  .amdhsa_accum_offset 128
  .amdhsa_group_segment_fixed_size 0
  .amdhsa_kernarg_size 120
  .amdhsa_user_sgpr_count 2
  .amdhsa_user_sgpr_kernarg_segment_ptr 1
  .amdhsa_system_sgpr_workgroup_id_x 1
.end_amdhsa_kernel
```
